```python
import torch

def _softmax(x, axis=-1):
    return torch.softmax(x, dim=axis)

def _gelu(x):
    return torch.nn.functional.gelu(x, approximate='tanh')

def _silu(x):
    return torch.nn.functional.silu(x)

def _sigmoid(x):
    return torch.sigmoid(x)

def _layernorm(x, axis=-1, eps=1e-05):
    m = x.mean(dim=axis, keepdim=True)
    v = x.var(dim=axis, keepdim=True, unbiased=False)
    return (x - m) / torch.sqrt(v + eps)

def _scatter_add(tgt, idx, src, axis=0):
    return tgt.clone().index_add_(axis, idx, src)

def _segment_sum(src, seg, n):
    out = torch.zeros((n,) + src.shape[1:], dtype=src.dtype)
    return out.index_add_(0, seg, src)

def _pad(x, pw):
    flat = tuple((v for pair in reversed(pw) for v in pair))
    return torch.nn.functional.pad(x, flat)
kernel_name = 'adaLN_cond__sliding_block_cached__glu_gated_bilinear__decode'

def setup_inputs():

    _w = lambda a: (lambda t: t.to(torch.bfloat16) if t.is_floating_point() else t)(torch.as_tensor(a))

    def _A_setup():
        B, Sq, D = (1, 1, 512)
        Hq, Hkv, Sk, Dh = (32, 8, 65536, 128)
        assert Hq % Hkv == 0, (Hq, Hkv)
        return {'x': _w((lambda *s: torch.randn(*s, dtype=torch.bfloat16) * 0.1)(B, Sq, D)), 'k_cache': _w((lambda *s: torch.randn(*s, dtype=torch.bfloat16) * 0.8)(B, Hkv, Sk, Dh)), 'v_cache': _w((lambda *s: torch.randn(*s, dtype=torch.bfloat16) * 3.2)(B, Hkv, Sk, Dh)), 'wq': _w((lambda *s: torch.randn(*s, dtype=torch.bfloat16) * 0.8)(D, Hq * Dh) * D ** (-0.5)), 'wo': _w((lambda *s: torch.randn(*s, dtype=torch.bfloat16) * 3.2)(Hq * Dh, D) * (Hq * Dh) ** (-0.5))}
    _A_in = _A_setup()

    def _B_setup():
        B, S, D, F = (1, 1, 512, 1792)
        return {'x': _w((lambda *s: torch.randn(*s, dtype=torch.bfloat16) * 0.1)(B, S, D)), 'w_gate': _w((lambda *s: torch.randn(*s, dtype=torch.bfloat16) * 3.2)(D, F) * D ** (-0.5)), 'w_up': _w((lambda *s: torch.randn(*s, dtype=torch.bfloat16) * 3.2)(D, F) * D ** (-0.5)), 'w_down': _w((lambda *s: torch.randn(*s, dtype=torch.bfloat16) * 3.2)(F, D) * F ** (-0.5))}
    _B_in = _B_setup()
    return {'A_x': _A_in['x'], 'A_k_cache': _A_in['k_cache'], 'A_v_cache': _A_in['v_cache'], 'A_wq': _A_in['wq'], 'A_wo': _A_in['wo'], 'B_x': _B_in['x'], 'B_w_gate': _B_in['w_gate'], 'B_w_up': _B_in['w_up'], 'B_w_down': _B_in['w_down'], 'c': _w((lambda *s: torch.randn(*s, dtype=torch.bfloat16) * 0.4)(1, 512) * 8.0), 'w_mod': _w((lambda *s: torch.randn(*s, dtype=torch.bfloat16) * 0.4)(512, 6 * 512) * 512 ** (-0.5) * 8.0)}

def reference(A_x, A_k_cache, A_v_cache, A_wq, A_wo, B_x, B_w_gate, B_w_up, B_w_down, c, w_mod):

    def _A_ref(x, k_cache, v_cache, wq, wo):
        B, Sq, D = x.shape
        Hq, Dh = (32, 128)
        Hkv, Sk = (k_cache.shape[1], k_cache.shape[2])
        W = min(4096, max(256, Sk // 4))
        rep = Hq // Hkv
        q = (lambda x, *d: x.permute(*d))((x @ wq).reshape(B, Sq, Hq, Dh), 0, 2, 1, 3)
        k = (lambda x, n, axis: torch.repeat_interleave(x, n, dim=axis))(k_cache[:, :, Sk - W:, :], rep, axis=1)
        v = (lambda x, n, axis: torch.repeat_interleave(x, n, dim=axis))(v_cache[:, :, Sk - W:, :], rep, axis=1)
        scores = torch.einsum('bhqd,bhkd->bhqk', q, k) * Dh ** (-0.5)
        p = _softmax(scores, axis=-1)
        o = torch.einsum('bhqk,bhkd->bhqd', p, v)
        return (lambda x, *d: x.permute(*d))(o, 0, 2, 1, 3).reshape(B, Sq, Hq * Dh) @ wo

    def _B_ref(x, w_gate, w_up, w_down):
        g = torch.einsum('bsd,df->bsf', x, w_gate)
        u = torch.einsum('bsd,df->bsf', x, w_up)
        h = g * u
        return torch.einsum('bsf,fd->bsd', h, w_down)
    x = A_x
    mod = (_silu(c) @ w_mod).reshape(c.shape[0], 6, 1, -1)
    sa, ca, ga, sb, cb, gb = (mod[:, 0].clone(), mod[:, 1].clone(), mod[:, 2].clone(), mod[:, 3].clone(), mod[:, 4].clone(), mod[:, 5].clone())
    h = _layernorm(x, axis=-1) * (1 + ca) + sa
    x = x + ga * _A_ref(h, A_k_cache, A_v_cache, A_wq, A_wo)
    h = _layernorm(x, axis=-1) * (1 + cb) + sb
    x = x + gb * _B_ref(h, B_w_gate, B_w_up, B_w_down)
    return x
```

```asm
; @launch grid=(256,1,1) block=(512,1,1) lds=139264
.amdgcn_target "amdgcn-amd-amdhsa--gfx950"
.text
.globl adaLN_cond__sliding_block_cached__glu_gated_bilinear__decode_kernel
.p2align 8
.type adaLN_cond__sliding_block_cached__glu_gated_bilinear__decode_kernel,@function
adaLN_cond__sliding_block_cached__glu_gated_bilinear__decode_kernel:
    s_load_dwordx16 s[16:31], s[0:1], 0
    s_load_dwordx8 s[32:39], s[0:1], 64
    s_load_dwordx2 s[40:41], s[0:1], 104
    v_lshrrev_b32 v1, 6, v0
    s_lshr_b32 s5, s2, 3
    v_readfirstlane_b32 s6, v1
    s_and_b32 s4, s2, 7
    s_cmp_lt_u32 s5, 16
    s_cbranch_scc1 L_ATT
    s_cmp_lt_u32 s5, 24
    s_cbranch_scc1 L_BD
    s_cmp_ge_u32 s5, 32
    s_cbranch_scc1 L_exit
    v_and_b32 v1, 63, v0
    v_bfe_u32 v4, v0, 4, 2
    v_and_b32 v5, 15, v0
    s_sub_u32 s7, s5, 24
    v_lshrrev_b32 v6, 3, v1
    v_and_b32 v7, 7, v1
    v_and_b32 v8, 2, v6
    v_xor_b32 v7, v7, v8
    v_mul_u32_u24 v6, 6144, v6
    v_lshl_add_u32 v6, v7, 4, v6
    v_xor_b32 v7, 64, v6
    s_lshr_b32 s3, s6, 2
    s_and_b32 s12, s6, 3
    s_lshl_b32 s10, s3, 3
    s_add_u32 s10, s10, s4
    s_lshl_b32 s10, s10, 7
    s_sub_u32 s11, 0x300000, s10
    s_lshl_b32 s14, s7, 2
    s_add_u32 s14, s14, s12
    s_mul_i32 s14, s14, 98304
    s_lshl_b32 s13, s6, 11
    s_add_u32 m0, s13, 98304
    s_lshl_b32 s15, s7, 7
    v_lshl_add_u32 v8, v1, 1, s15
    s_waitcnt lgkmcnt(0)
    global_load_ushort v9, v8, s[34:35]
    v_lshlrev_b32 v10, 4, v1
    global_load_dwordx4 v[20:23], v10, s[34:35]
    s_add_u32 s44, s36, s10
    s_addc_u32 s45, s37, 0
    s_and_b32 s45, s45, 0xffff
    s_mov_b32 s46, s11
    s_mov_b32 s47, 0x20000
    buffer_load_dwordx4 v6, s[44:47], s14 offen nt lds
    s_add_u32 m0, m0, 1024
    s_add_u32 s14, s14, 49152
    buffer_load_dwordx4 v7, s[44:47], s14 offen nt lds
    s_load_dword s42, s[40:41], 0
    v_lshrrev_b32 v14, 2, v5
    v_and_b32 v17, 2, v14
    v_and_b32 v18, 1, v4
    v_lshl_or_b32 v17, v18, 2, v17
    v_bfe_u32 v18, v5, 1, 1
    s_lshl_b32 s10, s12, 1
    v_add_u32 v18, s10, v18
    v_xor_b32 v17, v17, v18
    v_lshl_add_u32 v14, v4, 3, v14
    v_lshlrev_b32 v14, 7, v14
    v_lshl_add_u32 v14, v17, 4, v14
    v_and_b32 v17, 1, v5
    v_lshl_add_u32 v14, v17, 3, v14
    s_lshl_b32 s10, s3, 13
    s_add_u32 s10, s10, 98304
    v_add_u32 v14, s10, v14
    v_lshlrev_b32 v33, 4, v4
    v_add_u32 v15, 134400, v33
    v_lshlrev_b32 v8, 1, v1
    v_add_u32 v8, 134400, v8
    s_lshl_b32 s10, s4, 12
    s_lshl_b32 s11, s7, 9
    s_add_u32 s10, s10, s11
    s_lshl_b32 s11, s6, 6
    s_add_u32 s10, s10, s11
    s_mov_b32 s52, 0x00010001
    s_mov_b32 s53, s52
    s_mov_b32 s13, 0xff
    s_add_u32 s60, s10, 786432
    s_add_u32 s60, s40, s60
    s_addc_u32 s61, s41, 0
    s_add_u32 s62, s60, 65536
    s_addc_u32 s63, s61, 0
    s_waitcnt vmcnt(3)
    v_lshlrev_b32 v10, 16, v9
    v_mul_f32 v12, 0xbfb8aa3b, v10
    v_exp_f32 v12, v12
    s_nop 0
    v_add_f32 v12, 1.0, v12
    v_rcp_f32 v12, v12
    s_nop 0
    v_mul_f32 v10, v10, v12
    v_cvt_pk_bf16_f32 v9, v10, v10
    ds_write_b16 v8, v9
    s_waitcnt lgkmcnt(0)
    s_add_u32 s42, s42, 1
    s_and_b32 s42, s42, 0xff
    v_mov_b32 v25, s42
    s_waitcnt vmcnt(0)
    s_barrier
    ds_read_b128 v[128:131], v15 offset:0
    ds_read_b64_tr_b16 v[64:65], v14 offset:0
    ds_read_b64_tr_b16 v[66:67], v14 offset:512
    ds_read_b128 v[132:135], v15 offset:64
    ds_read_b64_tr_b16 v[68:69], v14 offset:4096
    ds_read_b64_tr_b16 v[70:71], v14 offset:4608
    s_waitcnt lgkmcnt(3)
    v_mfma_f32_16x16x32_bf16 v[28:31], v[64:67], v[128:131], 0
    s_waitcnt lgkmcnt(0)
    v_mfma_f32_16x16x32_bf16 v[28:31], v[68:71], v[132:135], v[28:31]
    s_mov_b64 exec, s[52:53]
    s_nop 6
    v_add_u32 v28, 0x80, v28
    v_add_u32 v29, 0x80, v29
    v_add_u32 v30, 0x80, v30
    v_add_u32 v31, 0x80, v31
    v_bfi_b32 v28, s13, v25, v28
    v_bfi_b32 v29, s13, v25, v29
    v_bfi_b32 v30, s13, v25, v30
    v_bfi_b32 v31, s13, v25, v31
    global_store_dwordx4 v33, v[28:31], s[60:61]
    s_mov_b64 exec, -1
    s_lshl_b32 s8, s4, 3
    s_add_u32 s8, s8, s7
    s_mov_b32 s9, s8
    s_cmp_ge_u32 s6, 4
    s_cbranch_scc1 L_AM_HELP
    s_branch L_AM1
.p2align 6
L_ATT:
    v_and_b32 v1, 63, v0
    v_bfe_u32 v4, v0, 4, 2
    v_and_b32 v5, 15, v0
    s_cmp_ge_u32 s6, 4
    s_cbranch_scc1 L_ATT_POLL
    v_xor_b32 v6, v5, v4
    v_lshlrev_b32 v6, 4, v6
    v_lshl_add_u32 v6, v4, 8, v6
    v_xor_b32 v7, 64, v6
    v_xor_b32 v8, 0x80, v6
    v_xor_b32 v9, 0xc0, v6
    v_lshlrev_b32 v10, 1, v4
    v_xor_b32 v10, v5, v10
    v_lshlrev_b32 v10, 4, v10
    v_lshl_add_u32 v10, v4, 8, v10
    v_xor_b32 v11, 0x80, v10
    s_lshl_b32 s7, s4, 24
    s_add_u32 s7, s7, 0xf00000
    s_lshl_b32 s8, s5, 2
    s_add_u32 s8, s8, s6
    s_lshl_b32 s8, s8, 10
    s_lshl_b32 s9, s6, 14
    s_waitcnt lgkmcnt(0)
    s_load_dword s42, s[40:41], 0
    s_add_u32 s44, s18, s7
    s_addc_u32 s45, s19, 0
    s_and_b32 s45, s45, 0xffff
    s_mov_b32 s46, 1048576
    s_mov_b32 s47, 0x20000
    s_add_u32 s48, s20, s7
    s_addc_u32 s49, s21, 0
    s_and_b32 s49, s49, 0xffff
    s_mov_b32 s50, 1048576
    s_mov_b32 s51, 0x20000
    s_lshl_b32 s12, s4, 12
    s_lshl_b32 s10, s5, 8
    s_add_u32 s12, s12, s10
    s_lshl_b32 s10, s6, 6
    s_add_u32 s12, s12, s10
    s_add_u32 s60, s12, 983040
    s_add_u32 s60, s40, s60
    s_addc_u32 s61, s41, 0
    s_waitcnt lgkmcnt(0)
    s_add_u32 s42, s42, 1
    s_and_b32 s42, s42, 0xff
    v_mov_b32 v28, s42
    v_mov_b32 v29, s42
    v_mov_b32 v30, s42
    v_mov_b32 v31, s42
    v_mov_b32 v27, 0
    v_lshlrev_b32 v32, 4, v5
    v_lshl_add_u32 v32, v4, 15, v32
    v_add_u32 v33, 0x4000, v32
    s_lshl_b32 s12, s4, 11
    s_lshl_b32 s10, s6, 9
    s_add_u32 s12, s12, s10
    s_add_u32 s68, s12, 1048576
    s_add_u32 s68, s40, s68
    s_addc_u32 s69, s41, 0
    s_mov_b32 m0, s9
    s_mov_b32 s10, s8
    buffer_load_dwordx4 v6, s[44:47], s10 offen nt lds
    s_add_u32 m0, m0, 1024
    s_xor_b32 s10, s8, 0x11000
    buffer_load_dwordx4 v7, s[44:47], s10 offen nt lds
    s_add_u32 m0, m0, 1024
    s_xor_b32 s10, s8, 0x22000
    buffer_load_dwordx4 v8, s[44:47], s10 offen nt lds
    s_add_u32 m0, m0, 1024
    s_xor_b32 s10, s8, 0x33000
    buffer_load_dwordx4 v9, s[44:47], s10 offen nt lds
    s_add_u32 m0, m0, 1024
    s_xor_b32 s10, s8, 0x44000
    buffer_load_dwordx4 v6, s[44:47], s10 offen nt lds
    s_add_u32 m0, m0, 1024
    s_xor_b32 s10, s8, 0x55000
    buffer_load_dwordx4 v7, s[44:47], s10 offen nt lds
    s_add_u32 m0, m0, 1024
    s_xor_b32 s10, s8, 0x66000
    buffer_load_dwordx4 v8, s[44:47], s10 offen nt lds
    s_add_u32 m0, m0, 1024
    s_xor_b32 s10, s8, 0x77000
    buffer_load_dwordx4 v9, s[44:47], s10 offen nt lds
    s_add_u32 m0, m0, 1024
    s_xor_b32 s10, s8, 0x88000
    buffer_load_dwordx4 v6, s[44:47], s10 offen nt lds
    s_add_u32 m0, m0, 1024
    s_xor_b32 s10, s8, 0x99000
    buffer_load_dwordx4 v7, s[44:47], s10 offen nt lds
    s_add_u32 m0, m0, 1024
    s_xor_b32 s10, s8, 0xaa000
    buffer_load_dwordx4 v8, s[44:47], s10 offen nt lds
    s_add_u32 m0, m0, 1024
    s_xor_b32 s10, s8, 0xbb000
    buffer_load_dwordx4 v9, s[44:47], s10 offen nt lds
    s_add_u32 m0, m0, 1024
    s_xor_b32 s10, s8, 0xcc000
    buffer_load_dwordx4 v6, s[44:47], s10 offen nt lds
    s_add_u32 m0, m0, 1024
    s_xor_b32 s10, s8, 0xdd000
    buffer_load_dwordx4 v7, s[44:47], s10 offen nt lds
    s_add_u32 m0, m0, 1024
    s_xor_b32 s10, s8, 0xee000
    buffer_load_dwordx4 v8, s[44:47], s10 offen nt lds
    s_add_u32 m0, m0, 1024
    s_xor_b32 s10, s8, 0xff000
    buffer_load_dwordx4 v9, s[44:47], s10 offen nt lds
    s_add_u32 m0, s9, 65536
    s_mov_b32 s10, s8
    buffer_load_dwordx4 v10, s[48:51], s10 offen nt lds
    s_add_u32 m0, m0, 1024
    s_xor_b32 s10, s8, 0x11000
    buffer_load_dwordx4 v11, s[48:51], s10 offen nt lds
    s_add_u32 m0, m0, 1024
    s_xor_b32 s10, s8, 0x22000
    buffer_load_dwordx4 v10, s[48:51], s10 offen nt lds
    s_add_u32 m0, m0, 1024
    s_xor_b32 s10, s8, 0x33000
    buffer_load_dwordx4 v11, s[48:51], s10 offen nt lds
    s_add_u32 m0, m0, 1024
    s_xor_b32 s10, s8, 0x44000
    buffer_load_dwordx4 v10, s[48:51], s10 offen nt lds
    s_add_u32 m0, m0, 1024
    s_xor_b32 s10, s8, 0x55000
    buffer_load_dwordx4 v11, s[48:51], s10 offen nt lds
    s_add_u32 m0, m0, 1024
    s_xor_b32 s10, s8, 0x66000
    buffer_load_dwordx4 v10, s[48:51], s10 offen nt lds
    s_add_u32 m0, m0, 1024
    s_xor_b32 s10, s8, 0x77000
    buffer_load_dwordx4 v11, s[48:51], s10 offen nt lds
    s_add_u32 m0, m0, 1024
    s_xor_b32 s10, s8, 0x88000
    s_mov_b64 exec, 1
    global_store_dwordx4 v27, v[28:31], s[60:61] offset:16
    s_mov_b64 exec, -1
    buffer_load_dwordx4 v10, s[48:51], s10 offen nt lds
    s_add_u32 m0, m0, 1024
    s_xor_b32 s10, s8, 0x99000
    buffer_load_dwordx4 v11, s[48:51], s10 offen nt lds
    s_add_u32 m0, m0, 1024
    s_xor_b32 s10, s8, 0xaa000
    buffer_load_dwordx4 v10, s[48:51], s10 offen nt lds
    s_add_u32 m0, m0, 1024
    s_xor_b32 s10, s8, 0xbb000
    buffer_load_dwordx4 v11, s[48:51], s10 offen nt lds
    s_add_u32 m0, m0, 1024
    s_xor_b32 s10, s8, 0xcc000
    buffer_load_dwordx4 v10, s[48:51], s10 offen nt lds
    s_add_u32 m0, m0, 1024
    s_xor_b32 s10, s8, 0xdd000
    buffer_load_dwordx4 v11, s[48:51], s10 offen nt lds
    s_add_u32 m0, m0, 1024
    s_xor_b32 s10, s8, 0xee000
    buffer_load_dwordx4 v10, s[48:51], s10 offen nt lds
    s_add_u32 m0, m0, 1024
    s_xor_b32 s10, s8, 0xff000
    buffer_load_dwordx4 v11, s[48:51], s10 offen nt lds
    s_branch L_ATT1
.p2align 6
L_BD:
    v_and_b32 v1, 63, v0
    v_bfe_u32 v4, v0, 4, 2
    v_and_b32 v5, 15, v0
    s_sub_u32 s7, s5, 16
    s_and_b32 s8, s6, 3
    v_xor_b32 v12, s8, v1
    v_lshlrev_b32 v12, 4, v12
    v_xor_b32 v13, 0x80, v12
    s_lshl_b32 s8, s4, 19
    s_lshl_b32 s9, s7, 10
    s_add_u32 s8, s8, s9
    s_sub_u32 s10, 0x400000, s8
    s_lshl_b32 s9, s6, 10
    s_lshl_b32 s11, s6, 13
    s_mov_b32 m0, s9
    s_waitcnt lgkmcnt(0)
    s_load_dword s42, s[40:41], 0
    s_add_u32 s44, s22, s8
    s_addc_u32 s45, s23, 0
    s_and_b32 s45, s45, 0xffff
    s_mov_b32 s46, s10
    s_mov_b32 s47, 0x20000
    s_cmp_lg_u32 s6, 7
    s_cbranch_scc1 L_BD_LD
    v_lshlrev_b32 v6, 4, v1
    global_load_dwordx4 v[8:11], v6, s[16:17]
    s_lshl_b32 s10, s4, 7
    v_lshlrev_b32 v24, 3, v5
    v_lshl_add_u32 v24, v4, 1, v24
    v_add_u32 v7, s10, v24
    global_load_ushort v26, v7, s[16:17]
    v_lshlrev_b32 v7, 4, v5
    v_lshl_add_u32 v7, v4, 10, v7
    s_lshl_b32 s10, s4, 12
    s_add_u32 s60, s10, 786432
    s_add_u32 s60, s40, s60
    s_addc_u32 s61, s41, 0
    global_load_dwordx4 v[32:35], v7, s[60:61] sc1
    global_load_dwordx4 v[36:39], v7, s[60:61] offset:512 sc1
    global_load_dwordx4 v[40:43], v7, s[60:61] offset:256 sc1
    global_load_dwordx4 v[44:47], v7, s[60:61] offset:768 sc1
L_BD_LD:
    buffer_load_dwordx4 v12, s[44:47], s11 offen nt lds
    s_add_u32 m0, m0, 8192
    s_add_u32 s11, s11, 0x10000
    buffer_load_dwordx4 v13, s[44:47], s11 offen nt lds
    s_add_u32 m0, m0, 8192
    s_add_u32 s11, s11, 0x10000
    buffer_load_dwordx4 v12, s[44:47], s11 offen nt lds
    s_add_u32 m0, m0, 8192
    s_add_u32 s11, s11, 0x10000
    buffer_load_dwordx4 v13, s[44:47], s11 offen nt lds
    s_add_u32 m0, m0, 8192
    s_add_u32 s11, s11, 0x10000
    buffer_load_dwordx4 v12, s[44:47], s11 offen nt lds
    s_add_u32 m0, m0, 8192
    s_add_u32 s11, s11, 0x10000
    buffer_load_dwordx4 v13, s[44:47], s11 offen nt lds
    s_add_u32 m0, m0, 8192
    s_add_u32 s11, s11, 0x10000
    buffer_load_dwordx4 v12, s[44:47], s11 offen nt lds
    s_add_u32 m0, m0, 8192
    s_add_u32 s11, s11, 0x10000
    buffer_load_dwordx4 v13, s[44:47], s11 offen nt lds
    s_branch L_BD1
L_ATT_POLL:
    s_cmp_lg_u32 s6, 7
    s_cbranch_scc1 L_ATT_NOPF
    s_getpc_b64 s[10:11]
L_pc:
    s_sub_u32 s10, s10, L_pc-adaLN_cond__sliding_block_cached__glu_gated_bilinear__decode_kernel
    s_subb_u32 s11, s11, 0
    s_lshl_b32 s12, s5, 10
    v_lshl_add_u32 v6, v1, 4, s12
    v_add_u32 v7, 0x4000, v6
    v_min_u32 v6, L_code_end-adaLN_cond__sliding_block_cached__glu_gated_bilinear__decode_kernel-16, v6
    v_min_u32 v7, L_code_end-adaLN_cond__sliding_block_cached__glu_gated_bilinear__decode_kernel-16, v7
    global_load_dwordx4 v[8:11], v6, s[10:11]
L_ATT_NOPF:
    s_sub_u32 s7, s6, 4
    v_lshrrev_b32 v18, 2, v5
    v_lshl_add_u32 v18, v4, 2, v18
    v_and_b32 v19, 7, v18
    v_lshlrev_b32 v19, 1, v19
    v_bfe_u32 v20, v5, 1, 1
    s_lshl_b32 s12, s7, 2
    v_add_u32 v20, s12, v20
    v_xor_b32 v19, v19, v20
    v_lshlrev_b32 v19, 4, v19
    v_lshl_add_u32 v18, v18, 8, v19
    v_and_b32 v19, 1, v5
    v_lshl_add_u32 v18, v19, 3, v18
    v_add_u32 v18, 65536, v18
    v_xor_b32 v19, 32, v18
    v_and_b32 v16, 3, v5
    v_lshlrev_b32 v21, 6, v4
    v_lshl_add_u32 v21, v16, 4, v21
    v_add_u32 v21, 133120, v21
    v_bfe_u32 v24, v5, 2, 1
    s_lshl_b32 s12, s7, 1
    v_add_u32 v24, s12, v24
    v_lshl_add_u32 v24, v24, 2, v4
    v_lshlrev_b32 v24, 4, v24
    v_lshl_add_u32 v24, v16, 9, v24
    s_lshl_b32 s12, s5, 11
    v_add_u32 v24, s12, v24
    s_mov_b32 s54, 0x00f000f0
    s_mov_b32 s55, s54
    s_mov_b32 s52, 0x00ff00ff
    s_mov_b32 s53, s52
    s_mov_b32 s13, 0xff
    v_lshlrev_b32 v22, 2, v16
    v_add_u32 v22, 132352, v22
    v_mov_b32 v23, 0xff800000
    ds_write_b32 v22, v23
    s_lshl_b32 s12, s4, 15
    s_waitcnt lgkmcnt(0)
    s_load_dword s42, s[40:41], 0
    s_add_u32 s64, s12, 262144
    s_add_u32 s64, s40, s64
    s_addc_u32 s65, s41, 0
    s_add_u32 s66, s12, 524288
    s_add_u32 s66, s40, s66
    s_addc_u32 s67, s41, 0
    s_lshl_b32 s12, s4, 12
    s_lshl_b32 s10, s7, 8
    s_add_u32 s12, s12, s10
    s_lshl_b32 s10, s5, 4
    s_add_u32 s12, s12, s10
    s_add_u32 s60, s12, 917504
    s_add_u32 s60, s40, s60
    s_addc_u32 s61, s41, 0
    v_lshlrev_b32 v26, 10, v16
    s_mov_b64 exec, s[52:53]
    global_load_dwordx4 v[8:11], v24, s[64:65] sc1
    s_mov_b64 exec, 15
    global_load_dwordx4 v[8:11], v26, s[60:61] sc1
    s_mov_b64 exec, -1
    s_waitcnt lgkmcnt(0)
    s_add_u32 s42, s42, 1
    s_and_b32 s42, s42, 0xff
    v_mov_b32 v25, s42
    s_barrier
    ds_read_b64_tr_b16 v[64:65], v18 offset:0
    ds_read_b64_tr_b16 v[66:67], v18 offset:4096
    ds_read_b64_tr_b16 v[96:97], v19 offset:0
    ds_read_b64_tr_b16 v[98:99], v19 offset:4096
    ds_read_b64_tr_b16 v[72:73], v18 offset:16384
    ds_read_b64_tr_b16 v[74:75], v18 offset:20480
    ds_read_b64_tr_b16 v[104:105], v19 offset:16384
    ds_read_b64_tr_b16 v[106:107], v19 offset:20480
    ds_read_b64_tr_b16 v[80:81], v18 offset:32768
    ds_read_b64_tr_b16 v[82:83], v18 offset:36864
    ds_read_b64_tr_b16 v[112:113], v19 offset:32768
    ds_read_b64_tr_b16 v[114:115], v19 offset:36864
    ds_read_b64_tr_b16 v[88:89], v18 offset:49152
    ds_read_b64_tr_b16 v[90:91], v18 offset:53248
    ds_read_b64_tr_b16 v[120:121], v19 offset:49152
    ds_read_b64_tr_b16 v[122:123], v19 offset:53248
    s_barrier
    ds_read_b64_tr_b16 v[68:69], v18 offset:8192
    ds_read_b64_tr_b16 v[70:71], v18 offset:12288
    ds_read_b64_tr_b16 v[100:101], v19 offset:8192
    ds_read_b64_tr_b16 v[102:103], v19 offset:12288
    ds_read_b64_tr_b16 v[76:77], v18 offset:24576
    ds_read_b64_tr_b16 v[78:79], v18 offset:28672
    ds_read_b64_tr_b16 v[108:109], v19 offset:24576
    ds_read_b64_tr_b16 v[110:111], v19 offset:28672
    ds_read_b64_tr_b16 v[84:85], v18 offset:40960
    ds_read_b64_tr_b16 v[86:87], v18 offset:45056
    ds_read_b64_tr_b16 v[116:117], v19 offset:40960
    ds_read_b64_tr_b16 v[118:119], v19 offset:45056
    ds_read_b64_tr_b16 v[92:93], v18 offset:57344
    ds_read_b64_tr_b16 v[94:95], v18 offset:61440
    ds_read_b64_tr_b16 v[124:125], v19 offset:57344
    ds_read_b64_tr_b16 v[126:127], v19 offset:61440
    s_barrier
    s_waitcnt lgkmcnt(0)
    s_barrier
    ds_read_b128 v[128:131], v21 offset:0
    ds_read_b128 v[132:135], v21 offset:256
    ds_read_b128 v[136:139], v21 offset:512
    ds_read_b128 v[140:143], v21 offset:768
    ds_read_b128 v[144:147], v21 offset:1024
    ds_read_b128 v[148:151], v21 offset:1280
    ds_read_b128 v[152:155], v21 offset:1536
    ds_read_b128 v[156:159], v21 offset:1792
    s_waitcnt lgkmcnt(7)
    v_mfma_f32_16x16x32_bf16 v[40:43], v[64:67], v[128:131], 0
    v_mfma_f32_16x16x32_bf16 v[44:47], v[96:99], v[128:131], 0
    s_waitcnt lgkmcnt(6)
    v_mfma_f32_16x16x32_bf16 v[40:43], v[68:71], v[132:135], v[40:43]
    v_mfma_f32_16x16x32_bf16 v[44:47], v[100:103], v[132:135], v[44:47]
    s_waitcnt lgkmcnt(5)
    v_mfma_f32_16x16x32_bf16 v[40:43], v[72:75], v[136:139], v[40:43]
    v_mfma_f32_16x16x32_bf16 v[44:47], v[104:107], v[136:139], v[44:47]
    s_waitcnt lgkmcnt(4)
    v_mfma_f32_16x16x32_bf16 v[40:43], v[76:79], v[140:143], v[40:43]
    v_mfma_f32_16x16x32_bf16 v[44:47], v[108:111], v[140:143], v[44:47]
    s_waitcnt lgkmcnt(3)
    v_mfma_f32_16x16x32_bf16 v[40:43], v[80:83], v[144:147], v[40:43]
    v_mfma_f32_16x16x32_bf16 v[44:47], v[112:115], v[144:147], v[44:47]
    s_waitcnt lgkmcnt(2)
    v_mfma_f32_16x16x32_bf16 v[40:43], v[84:87], v[148:151], v[40:43]
    v_mfma_f32_16x16x32_bf16 v[44:47], v[116:119], v[148:151], v[44:47]
    s_waitcnt lgkmcnt(1)
    v_mfma_f32_16x16x32_bf16 v[40:43], v[88:91], v[152:155], v[40:43]
    v_mfma_f32_16x16x32_bf16 v[44:47], v[120:123], v[152:155], v[44:47]
    s_waitcnt lgkmcnt(0)
    v_mfma_f32_16x16x32_bf16 v[40:43], v[92:95], v[156:159], v[40:43]
    v_mfma_f32_16x16x32_bf16 v[44:47], v[124:127], v[156:159], v[44:47]
    s_nop 7
    v_cndmask_b32 v40, v40, v44, s[54:55]
    v_cndmask_b32 v41, v41, v45, s[54:55]
    v_cndmask_b32 v42, v42, v46, s[54:55]
    v_cndmask_b32 v43, v43, v47, s[54:55]
    v_bfi_b32 v40, s13, v25, v40
    v_bfi_b32 v41, s13, v25, v41
    v_bfi_b32 v42, s13, v25, v42
    v_bfi_b32 v43, s13, v25, v43
    s_mov_b64 exec, s[52:53]
    global_store_dwordx4 v24, v[40:43], s[64:65]
    s_barrier
    global_store_dwordx4 v24, v[40:43], s[66:67] sc1
    s_endpgm
L_BD1:
    v_lshrrev_b32 v16, 2, v5
    v_and_b32 v17, 3, v5
    v_and_b32 v18, 1, v4
    v_lshlrev_b32 v19, 1, v17
    s_lshl_b32 s8, s6, 3
    v_add_u32 v19, s8, v19
    v_xor_b32 v19, v19, v16
    v_lshlrev_b32 v20, 3, v18
    v_xor_b32 v19, v19, v20
    v_lshl_add_u32 v16, v4, 3, v16
    v_lshlrev_b32 v16, 10, v16
    v_lshl_add_u32 v16, v19, 4, v16
    v_and_b32 v19, 1, v5
    v_lshl_add_u32 v16, v19, 3, v16
    v_xor_b32 v19, v17, v18
    v_lshlrev_b32 v19, 4, v19
    v_lshl_add_u32 v19, v4, 6, v19
    s_lshl_b32 s8, s7, 11
    s_lshl_b32 s10, s6, 8
    s_add_u32 s8, s8, s10
    v_add_u32 v19, s8, v19
    v_lshlrev_b32 v18, 4, v4
    v_add_u32 v18, 131072, v18
    s_lshl_b32 s12, s4, 14
    s_mov_b32 s52, 0x22222222
    s_mov_b32 s53, s52
    s_lshl_b64 s[54:55], s[52:53], 1
    s_lshl_b64 s[56:57], s[52:53], 2
    s_mov_b32 s58, 0x000f000f
    s_mov_b32 s59, s58
    s_mov_b32 s13, 0xff
    s_add_u32 s64, s12, 1048576
    s_add_u32 s64, s40, s64
    s_addc_u32 s65, s41, 0
    v_mov_b32 v20, 134976
    v_mov_b32 v21, 0
    ds_write_b32 v20, v21
    s_lshl_b32 s10, s4, 12
    s_add_u32 s60, s10, 786432
    s_add_u32 s60, s40, s60
    s_addc_u32 s61, s41, 0
    s_add_u32 s62, s60, 65536
    s_addc_u32 s63, s61, 0
    v_lshlrev_b32 v7, 4, v5
    v_lshl_add_u32 v7, v4, 10, v7
    v_lshlrev_b32 v24, 3, v5
    v_lshl_add_u32 v24, v4, 1, v24
    v_add_u32 v24, 131072, v24
    s_waitcnt lgkmcnt(0)
    s_add_u32 s42, s42, 1
    s_and_b32 s42, s42, 0xff
    v_mov_b32 v25, s42
    s_cmp_lg_u32 s6, 7
    s_cbranch_scc1 L_BD_NOLN
    s_waitcnt vmcnt(12)
    v_lshlrev_b32 v48, 16, v8
    v_and_b32 v49, 0xffff0000, v8
    v_lshlrev_b32 v50, 16, v9
    v_and_b32 v51, 0xffff0000, v9
    v_lshlrev_b32 v52, 16, v10
    v_and_b32 v53, 0xffff0000, v10
    v_lshlrev_b32 v54, 16, v11
    v_and_b32 v55, 0xffff0000, v11
    v_add_f32 v20, v48, v49
    v_mul_f32 v21, v48, v48
    v_fmac_f32 v21, v49, v49
    v_add_f32 v20, v20, v50
    v_fmac_f32 v21, v50, v50
    v_add_f32 v20, v20, v51
    v_fmac_f32 v21, v51, v51
    v_add_f32 v20, v20, v52
    v_fmac_f32 v21, v52, v52
    v_add_f32 v20, v20, v53
    v_fmac_f32 v21, v53, v53
    v_add_f32 v20, v20, v54
    v_fmac_f32 v21, v54, v54
    v_add_f32 v20, v20, v55
    v_fmac_f32 v21, v55, v55
    s_nop 1
    v_add_f32_dpp v20, v20, v20 row_ror:1 row_mask:0xf bank_mask:0xf
    v_add_f32_dpp v21, v21, v21 row_ror:1 row_mask:0xf bank_mask:0xf
    s_nop 1
    v_add_f32_dpp v20, v20, v20 row_ror:2 row_mask:0xf bank_mask:0xf
    v_add_f32_dpp v21, v21, v21 row_ror:2 row_mask:0xf bank_mask:0xf
    s_nop 1
    v_add_f32_dpp v20, v20, v20 row_ror:4 row_mask:0xf bank_mask:0xf
    v_add_f32_dpp v21, v21, v21 row_ror:4 row_mask:0xf bank_mask:0xf
    s_nop 1
    v_add_f32_dpp v20, v20, v20 row_ror:8 row_mask:0xf bank_mask:0xf
    v_add_f32_dpp v21, v21, v21 row_ror:8 row_mask:0xf bank_mask:0xf
    v_mov_b32 v22, v20
    s_nop 1
    v_permlane16_swap_b32 v20, v22
    v_add_f32 v20, v20, v22
    v_mov_b32 v22, v20
    s_nop 1
    v_permlane32_swap_b32 v20, v22
    v_add_f32 v20, v20, v22
    v_mov_b32 v22, v21
    s_nop 1
    v_permlane16_swap_b32 v21, v22
    v_add_f32 v21, v21, v22
    v_mov_b32 v22, v21
    s_nop 1
    v_permlane32_swap_b32 v21, v22
    v_add_f32 v21, v21, v22
    v_mul_f32 v20, 0x3b000000, v20
    v_mul_f32 v21, 0x3b000000, v21
    v_fma_f32 v21, -v20, v20, v21
    v_max_f32 v21, 0, v21
    v_cvt_pk_bf16_f32 v20, 0, v20
    v_cvt_pk_bf16_f32 v21, 0, v21
    v_add_f32 v21, 0x3727c5ac, v21
    v_cvt_pk_bf16_f32 v21, 0, v21
    v_sqrt_f32 v21, v21
    s_nop 0
    v_cvt_pk_bf16_f32 v21, 0, v21
    v_rcp_f32 v21, v21
    s_nop 0
    v_lshlrev_b32 v26, 16, v26
    v_sub_f32 v26, v26, v20
    v_cvt_pk_bf16_f32 v26, 0, v26
    v_mul_f32 v26, v26, v21
    v_cvt_pk_bf16_f32 v26, 0, v26
    s_waitcnt vmcnt(0)
    global_load_dwordx4 v[32:35], v7, s[60:61] sc1
    global_load_dwordx4 v[36:39], v7, s[60:61] offset:512 sc1
    global_load_dwordx4 v[40:43], v7, s[60:61] offset:256 sc1
    global_load_dwordx4 v[44:47], v7, s[60:61] offset:768 sc1
    s_branch L_BD_B0
L_BD_NOLN:
    s_waitcnt vmcnt(0)
L_BD_B0:
    s_barrier
    ds_read_b64_tr_b16 v[64:65], v16 offset:0
    ds_read_b64_tr_b16 v[66:67], v16 offset:4096
    ds_read_b64_tr_b16 v[68:69], v16 offset:32768
    ds_read_b64_tr_b16 v[70:71], v16 offset:36864
    v_xor_b32 v17, 8, v16
    ds_read_b64_tr_b16 v[72:73], v17 offset:0
    ds_read_b64_tr_b16 v[74:75], v17 offset:4096
    ds_read_b64_tr_b16 v[76:77], v17 offset:32768
    ds_read_b64_tr_b16 v[78:79], v17 offset:36864
    v_xor_b32 v17, 16, v16
    ds_read_b64_tr_b16 v[80:81], v17 offset:0
    ds_read_b64_tr_b16 v[82:83], v17 offset:4096
    ds_read_b64_tr_b16 v[84:85], v17 offset:32768
    ds_read_b64_tr_b16 v[86:87], v17 offset:36864
    v_xor_b32 v17, 24, v16
    ds_read_b64_tr_b16 v[88:89], v17 offset:0
    ds_read_b64_tr_b16 v[90:91], v17 offset:4096
    ds_read_b64_tr_b16 v[92:93], v17 offset:32768
    ds_read_b64_tr_b16 v[94:95], v17 offset:36864
    s_cmp_lg_u32 s6, 7
    s_cbranch_scc1 L_BD_NOH
    s_mov_b32 s43, 0
    s_branch L_pck_29
L_poll_27:
    global_load_dwordx4 v[32:35], v7, s[60:61] sc1
    global_load_dwordx4 v[36:39], v7, s[60:61] offset:512 sc1
    global_load_dwordx4 v[40:43], v7, s[60:61] offset:256 sc1
    global_load_dwordx4 v[44:47], v7, s[60:61] offset:768 sc1
L_pck_29:
    s_waitcnt vmcnt(0)
    v_xor_b32 v32, s42, v32
    v_xor_b32 v33, s42, v33
    v_xor_b32 v34, s42, v34
    v_xor_b32 v35, s42, v35
    v_xor_b32 v36, s42, v36
    v_xor_b32 v37, s42, v37
    v_xor_b32 v38, s42, v38
    v_xor_b32 v39, s42, v39
    v_xor_b32 v40, s42, v40
    v_xor_b32 v41, s42, v41
    v_xor_b32 v42, s42, v42
    v_xor_b32 v43, s42, v43
    v_xor_b32 v44, s42, v44
    v_xor_b32 v45, s42, v45
    v_xor_b32 v46, s42, v46
    v_xor_b32 v47, s42, v47
    v_or3_b32 v20, v32, v33, v34
    v_or3_b32 v20, v20, v35, v36
    v_or3_b32 v20, v20, v37, v38
    v_or3_b32 v20, v20, v39, v40
    v_or3_b32 v20, v20, v41, v42
    v_or3_b32 v20, v20, v43, v44
    v_or3_b32 v20, v20, v45, v46
    v_or_b32 v20, v20, v47
    v_and_b32 v20, 0xff, v20
    v_cmp_ne_u32 vcc, 0, v20
    s_cbranch_vccz L_ok_28
    s_mov_b64 exec, vcc
    s_add_u32 s43, s43, 1
    s_cmp_ge_u32 s43, 256
    s_cselect_b64 s[60:61], s[62:63], s[60:61]
    s_cmp_lt_u32 s43, 1048576
    s_cbranch_scc1 L_poll_27
L_ok_28:
    s_mov_b64 exec, -1
    v_add_f32 v32, v32, v36
    v_add_f32 v33, v33, v37
    v_add_f32 v34, v34, v38
    v_add_f32 v35, v35, v39
    v_add_f32 v40, v40, v44
    v_add_f32 v41, v41, v45
    v_add_f32 v42, v42, v46
    v_add_f32 v43, v43, v47
    v_permlane32_swap_b32 v32, v34
    v_permlane32_swap_b32 v33, v35
    s_nop 0
    v_permlane32_swap_b32 v40, v42
    v_permlane32_swap_b32 v41, v43
    v_add_f32 v32, v32, v34
    v_add_f32 v33, v33, v35
    v_add_f32 v40, v40, v42
    v_add_f32 v41, v41, v43
    s_nop 0
    v_permlane16_swap_b32 v32, v33
    v_permlane16_swap_b32 v40, v41
    v_add_f32 v32, v32, v33
    v_add_f32 v40, v40, v41
    v_cvt_pk_bf16_f32 v32, 0, v32
    v_cvt_pk_bf16_f32 v40, 0, v40
    v_add_f32 v40, 1.0, v40
    v_cvt_pk_bf16_f32 v40, 0, v40
    v_mul_f32 v40, v40, v26
    v_cvt_pk_bf16_f32 v40, 0, v40
    v_add_f32 v40, v40, v32
    v_cvt_pk_bf16_f32 v40, v40, v40
    ds_write_b16 v24, v40
L_BD_NOH:
    s_waitcnt lgkmcnt(0)
    s_barrier
    ds_read_b128 v[128:131], v18
    ds_read_b128 v[132:135], v18 offset:64
    s_waitcnt lgkmcnt(1)
    v_mfma_f32_16x16x32_bf16 v[136:139], v[64:67], v[128:131], 0
    v_mfma_f32_16x16x32_bf16 v[140:143], v[72:75], v[128:131], 0
    v_mfma_f32_16x16x32_bf16 v[144:147], v[80:83], v[128:131], 0
    v_mfma_f32_16x16x32_bf16 v[148:151], v[88:91], v[128:131], 0
    s_waitcnt lgkmcnt(0)
    v_mfma_f32_16x16x32_bf16 v[136:139], v[68:71], v[132:135], v[136:139]
    v_mfma_f32_16x16x32_bf16 v[140:143], v[76:79], v[132:135], v[140:143]
    v_mfma_f32_16x16x32_bf16 v[144:147], v[84:87], v[132:135], v[144:147]
    v_mfma_f32_16x16x32_bf16 v[148:151], v[92:95], v[132:135], v[148:151]
    s_nop 5
    v_cndmask_b32 v28, v136, v140, s[52:53]
    v_cndmask_b32 v29, v137, v141, s[52:53]
    v_cndmask_b32 v30, v138, v142, s[52:53]
    v_cndmask_b32 v31, v139, v143, s[52:53]
    v_cndmask_b32 v28, v28, v144, s[54:55]
    v_cndmask_b32 v29, v29, v145, s[54:55]
    v_cndmask_b32 v30, v30, v146, s[54:55]
    v_cndmask_b32 v31, v31, v147, s[54:55]
    v_cndmask_b32 v28, v28, v148, s[56:57]
    v_cndmask_b32 v29, v29, v149, s[56:57]
    v_cndmask_b32 v30, v30, v150, s[56:57]
    v_cndmask_b32 v31, v31, v151, s[56:57]
    v_add_u32 v28, 0x80, v28
    v_add_u32 v29, 0x80, v29
    v_add_u32 v30, 0x80, v30
    v_add_u32 v31, 0x80, v31
    v_bfi_b32 v28, s13, v25, v28
    v_bfi_b32 v29, s13, v25, v29
    v_bfi_b32 v30, s13, v25, v30
    v_bfi_b32 v31, s13, v25, v31
    s_mov_b64 exec, s[58:59]
    global_store_dwordx4 v19, v[28:31], s[64:65] sc1
    s_mov_b64 exec, -1
    s_cmp_ge_u32 s6, 4
    s_cbranch_scc1 L_BM_NOWO
    s_add_u32 s11, s7, 8
    s_lshl_b32 s10, s4, 12
    s_lshl_b32 s12, s11, 8
    s_add_u32 s10, s10, s12
    s_add_u32 s60, s10, 983056
    s_add_u32 s60, s40, s60
    s_addc_u32 s61, s41, 0
    v_mov_b32 v32, 0
    s_mov_b32 s43, 0
    s_mov_b64 exec, 1
L_fw_30:
    global_load_dwordx4 v[34:37], v32, s[60:61] sc1
    s_waitcnt vmcnt(0)
    v_bitop3_b32 v33, v34, v37, s42 bitop3:0x7e
    v_cmp_ne_u32 vcc, 0, v33
    s_cbranch_vccz L_fwok_31
    s_sleep 1
    s_add_u32 s43, s43, 1
    s_cmp_lt_u32 s43, 64
    s_cbranch_scc1 L_fw_30
L_fwok_31:
    s_mov_b64 exec, -1
    s_lshl_b32 s10, s4, 19
    s_lshl_b32 s12, s7, 7
    s_add_u32 s10, s10, s12
    s_lshl_b32 s12, s6, 16
    s_add_u32 s10, s10, s12
    s_add_u32 s10, s10, 0x40000
    s_add_u32 s60, s24, s10
    s_addc_u32 s61, s25, 0
    v_lshlrev_b32 v40, 10, v1
    global_load_dword v41, v40, s[60:61] nt
L_BM_NOWO:
    s_cmp_lt_u32 s4, 7
    s_cbranch_scc1 L_BM
    s_endpgm
L_BM:
    s_lshl_b32 s10, s6, 7
    v_lshlrev_b32 v10, 3, v5
    v_lshl_add_u32 v10, v4, 1, v10
    v_add_u32 v10, s10, v10
    global_load_ushort v60, v10, s[16:17]
    s_lshl_b32 s8, s4, 3
    s_add_u32 s8, s8, s7
    s_mov_b32 s9, s8
    s_cmp_ge_u32 s6, 4
    s_cbranch_scc1 L_AM_H_MOD
    s_branch L_AM_NSP
L_AM_HELP:
    s_cmp_eq_u32 s6, 6
    s_cbranch_scc1 L_AM_H_SILU
    v_mov_b32 v7, 134976
    v_mov_b32 v8, 0
    v_mov_b32 v9, 0
    v_mov_b32 v10, 0
    v_mov_b32 v11, 0
    ds_write_b128 v7, v[8:11]
    s_waitcnt lgkmcnt(0)
    s_branch L_AM_H_MR
L_AM_H_SILU:
    v_lshlrev_b32 v6, 4, v1
    v_add_u32 v7, 135168, v6
    v_mov_b32 v8, v20
    v_mov_b32 v9, v21
    v_mov_b32 v10, v22
    v_mov_b32 v11, v23
    v_lshlrev_b32 v12, 16, v8
    v_and_b32 v13, 0xffff0000, v8
    v_lshlrev_b32 v14, 16, v9
    v_and_b32 v15, 0xffff0000, v9
    v_lshlrev_b32 v16, 16, v10
    v_and_b32 v17, 0xffff0000, v10
    v_lshlrev_b32 v18, 16, v11
    v_and_b32 v19, 0xffff0000, v11
    v_mul_f32 v20, 0xbfb8aa3b, v12
    v_mul_f32 v21, 0xbfb8aa3b, v13
    v_mul_f32 v22, 0xbfb8aa3b, v14
    v_mul_f32 v23, 0xbfb8aa3b, v15
    v_mul_f32 v24, 0xbfb8aa3b, v16
    v_mul_f32 v25, 0xbfb8aa3b, v17
    v_mul_f32 v26, 0xbfb8aa3b, v18
    v_mul_f32 v27, 0xbfb8aa3b, v19
    v_exp_f32 v20, v20
    v_exp_f32 v21, v21
    v_exp_f32 v22, v22
    v_exp_f32 v23, v23
    v_exp_f32 v24, v24
    v_exp_f32 v25, v25
    v_exp_f32 v26, v26
    v_exp_f32 v27, v27
    v_add_f32 v20, 1.0, v20
    v_add_f32 v21, 1.0, v21
    v_add_f32 v22, 1.0, v22
    v_add_f32 v23, 1.0, v23
    v_add_f32 v24, 1.0, v24
    v_add_f32 v25, 1.0, v25
    v_add_f32 v26, 1.0, v26
    v_add_f32 v27, 1.0, v27
    v_rcp_f32 v20, v20
    v_rcp_f32 v21, v21
    v_rcp_f32 v22, v22
    v_rcp_f32 v23, v23
    v_rcp_f32 v24, v24
    v_rcp_f32 v25, v25
    v_rcp_f32 v26, v26
    v_rcp_f32 v27, v27
    v_mul_f32 v12, v12, v20
    v_mul_f32 v13, v13, v21
    v_mul_f32 v14, v14, v22
    v_mul_f32 v15, v15, v23
    v_mul_f32 v16, v16, v24
    v_mul_f32 v17, v17, v25
    v_mul_f32 v18, v18, v26
    v_mul_f32 v19, v19, v27
    v_cvt_pk_bf16_f32 v8, v12, v13
    v_cvt_pk_bf16_f32 v9, v14, v15
    v_cvt_pk_bf16_f32 v10, v16, v17
    v_cvt_pk_bf16_f32 v11, v18, v19
    ds_write_b128 v7, v[8:11]
    s_waitcnt lgkmcnt(0)
L_AM_H_MR:
    s_barrier
    s_mov_b64 exec, s[52:53]
    global_store_dwordx4 v33, v[28:31], s[62:63] sc1
    s_mov_b64 exec, -1
    v_lshrrev_b32 v6, 3, v1
    v_and_b32 v7, 7, v1
    v_and_b32 v8, 2, v6
    v_xor_b32 v7, v7, v8
    v_mul_u32_u24 v6, 6144, v6
    v_lshl_add_u32 v6, v7, 4, v6
    v_xor_b32 v7, 64, v6
    s_lshr_b32 s10, s8, 1
    s_lshl_b32 s10, s10, 7
    s_add_u32 s10, s10, 2048
    s_sub_u32 s11, 0x300000, s10
    s_add_u32 s44, s36, s10
    s_addc_u32 s45, s37, 0
    s_and_b32 s45, s45, 0xffff
    s_mov_b32 s46, s11
    s_mov_b32 s47, 0x20000
    s_sub_u32 s12, s6, 4
    s_and_b32 s3, s8, 1
    s_lshl_b32 s11, s3, 2
    s_add_u32 s11, s11, s12
    s_mul_i32 s11, s11, 393216
    s_lshl_b32 s13, s12, 13
    s_add_u32 m0, s13, 98304
    s_nop 0
    buffer_load_dwordx4 v6, s[44:47], s11 offen nt lds
    s_add_u32 m0, m0, 1024
    s_add_u32 s11, s11, 49152
    buffer_load_dwordx4 v7, s[44:47], s11 offen nt lds
    s_add_u32 m0, m0, 1024
    s_add_u32 s11, s11, 49152
    buffer_load_dwordx4 v6, s[44:47], s11 offen nt lds
    s_add_u32 m0, m0, 1024
    s_add_u32 s11, s11, 49152
    buffer_load_dwordx4 v7, s[44:47], s11 offen nt lds
    s_add_u32 m0, m0, 1024
    s_add_u32 s11, s11, 49152
    buffer_load_dwordx4 v6, s[44:47], s11 offen nt lds
    s_add_u32 m0, m0, 1024
    s_add_u32 s11, s11, 49152
    buffer_load_dwordx4 v7, s[44:47], s11 offen nt lds
    s_add_u32 m0, m0, 1024
    s_add_u32 s11, s11, 49152
    buffer_load_dwordx4 v6, s[44:47], s11 offen nt lds
    s_add_u32 m0, m0, 1024
    s_add_u32 s11, s11, 49152
    buffer_load_dwordx4 v7, s[44:47], s11 offen nt lds
    v_mov_b32 v20, 134976
    v_mov_b32 v21, 1
    s_mov_b64 exec, 1
    ds_add_u32 v20, v21 offset:8
    s_mov_b64 exec, -1
    s_sub_u32 s12, s6, 4
    s_and_b32 s3, s8, 1
    v_lshrrev_b32 v16, 2, v5
    v_and_b32 v17, 2, v16
    v_and_b32 v18, 1, v4
    v_lshl_or_b32 v17, v18, 2, v17
    v_bfe_u32 v18, v5, 1, 1
    s_lshl_b32 s11, s12, 1
    v_add_u32 v18, s11, v18
    v_xor_b32 v17, v17, v18
    v_lshl_add_u32 v16, v4, 3, v16
    v_lshlrev_b32 v16, 7, v16
    v_lshl_add_u32 v16, v17, 4, v16
    v_and_b32 v17, 1, v5
    v_lshl_add_u32 v16, v17, 3, v16
    v_add_u32 v16, 98304, v16
    v_lshlrev_b32 v19, 4, v4
    s_lshl_b32 s11, s3, 9
    s_add_u32 s11, s11, 135168
    v_add_u32 v18, s11, v19
    s_lshl_b32 s11, s3, 13
    s_lshr_b32 s10, s8, 1
    s_lshl_b32 s10, s10, 8
    s_add_u32 s11, s11, s10
    s_lshl_b32 s10, s12, 6
    s_add_u32 s11, s11, s10
    s_mov_b32 s52, 0x00010001
    s_mov_b32 s53, s52
    s_mov_b32 s13, 0xff
    v_mov_b32 v27, s42
    s_add_u32 s60, s11, 98304
    s_add_u32 s60, s40, s60
    s_addc_u32 s61, s41, 0
    v_mov_b32 v20, 134976
    v_mov_b32 v21, 1
    s_waitcnt vmcnt(0)
    s_mov_b64 exec, 1
    ds_add_u32 v20, v21
    s_mov_b64 exec, -1
L_AM_H_SYNC:
    ds_read_b32 v21, v20
    s_waitcnt lgkmcnt(0)
    v_cmp_gt_u32 vcc, 4, v21
    s_cbranch_vccnz L_AM_H_SYNC
    ds_read_b64_tr_b16 v[64:65], v16 offset:0
    ds_read_b64_tr_b16 v[66:67], v16 offset:512
    ds_read_b64_tr_b16 v[68:69], v16 offset:4096
    ds_read_b64_tr_b16 v[70:71], v16 offset:4608
    ds_read_b64_tr_b16 v[72:73], v16 offset:8192
    ds_read_b64_tr_b16 v[74:75], v16 offset:8704
    ds_read_b64_tr_b16 v[76:77], v16 offset:12288
    ds_read_b64_tr_b16 v[78:79], v16 offset:12800
    ds_read_b64_tr_b16 v[80:81], v16 offset:16384
    ds_read_b64_tr_b16 v[82:83], v16 offset:16896
    ds_read_b64_tr_b16 v[84:85], v16 offset:20480
    ds_read_b64_tr_b16 v[86:87], v16 offset:20992
    ds_read_b64_tr_b16 v[88:89], v16 offset:24576
    ds_read_b64_tr_b16 v[90:91], v16 offset:25088
    ds_read_b64_tr_b16 v[92:93], v16 offset:28672
    ds_read_b64_tr_b16 v[94:95], v16 offset:29184
    ds_read_b128 v[128:131], v18 offset:0
    ds_read_b128 v[132:135], v18 offset:64
    ds_read_b128 v[136:139], v18 offset:128
    ds_read_b128 v[140:143], v18 offset:192
    ds_read_b128 v[144:147], v18 offset:256
    ds_read_b128 v[148:151], v18 offset:320
    ds_read_b128 v[152:155], v18 offset:384
    ds_read_b128 v[156:159], v18 offset:448
    s_waitcnt lgkmcnt(7)
    v_mfma_f32_16x16x32_bf16 v[28:31], v[64:67], v[128:131], 0
    s_waitcnt lgkmcnt(6)
    v_mfma_f32_16x16x32_bf16 v[28:31], v[68:71], v[132:135], v[28:31]
    s_waitcnt lgkmcnt(5)
    v_mfma_f32_16x16x32_bf16 v[28:31], v[72:75], v[136:139], v[28:31]
    s_waitcnt lgkmcnt(4)
    v_mfma_f32_16x16x32_bf16 v[28:31], v[76:79], v[140:143], v[28:31]
    s_waitcnt lgkmcnt(3)
    v_mfma_f32_16x16x32_bf16 v[28:31], v[80:83], v[144:147], v[28:31]
    s_waitcnt lgkmcnt(2)
    v_mfma_f32_16x16x32_bf16 v[28:31], v[84:87], v[148:151], v[28:31]
    s_waitcnt lgkmcnt(1)
    v_mfma_f32_16x16x32_bf16 v[28:31], v[88:91], v[152:155], v[28:31]
    s_waitcnt lgkmcnt(0)
    v_mfma_f32_16x16x32_bf16 v[28:31], v[92:95], v[156:159], v[28:31]
    s_nop 7
    v_bfi_b32 v28, s13, v27, v28
    v_bfi_b32 v29, s13, v27, v29
    v_bfi_b32 v30, s13, v27, v30
    v_bfi_b32 v31, s13, v27, v31
    s_mov_b64 exec, s[52:53]
    global_store_dwordx4 v19, v[28:31], s[60:61] sc1
    s_mov_b64 exec, -1
    v_mov_b32 v20, 134976
    v_mov_b32 v21, 1
    s_mov_b64 exec, 1
    ds_add_u32 v20, v21 offset:4
    s_mov_b64 exec, -1
    s_lshl_b32 s8, s6, 8
    v_lshlrev_b32 v6, 4, v5
    v_lshl_add_u32 v6, v4, 13, v6
    v_add_u32 v6, s8, v6
    v_add_u32 v7, 0x1000, v6
    s_lshr_b32 s8, s6, 1
    s_lshl_b32 s8, s8, 10
    v_lshlrev_b32 v8, 4, v1
    v_add_u32 v8, s8, v8
    s_lshl_b32 s8, s6, 7
    s_add_u32 s8, s8, 132096
    v_lshlrev_b32 v9, 1, v4
    v_lshl_add_u32 v9, v5, 3, v9
    v_add_u32 v9, s8, v9
    s_lshl_b32 s8, s7, 8
    s_and_b32 s10, s6, 3
    s_lshl_b32 s10, s10, 6
    s_add_u32 s8, s8, s10
    v_lshlrev_b32 v19, 4, v4
    v_add_u32 v23, s8, v19
    v_add_u32 v18, 131072, v19
    v_mov_b32 v25, s42
    s_mov_b32 s13, 0xff
    s_mov_b32 s52, 0x00010001
    s_mov_b32 s53, s52
    s_lshl_b32 s12, s4, 11
    s_add_u32 s68, s12, 65536
    s_add_u32 s68, s40, s68
    s_addc_u32 s69, s41, 0
    s_lshl_b32 s12, s4, 15
    s_add_u32 s54, s12, 262144
    s_add_u32 s54, s40, s54
    s_addc_u32 s55, s41, 0
    s_add_u32 s56, s12, 524288
    s_add_u32 s56, s40, s56
    s_addc_u32 s57, s41, 0
    s_lshl_b32 s12, s4, 12
    s_add_u32 s64, s12, 917504
    s_add_u32 s64, s40, s64
    s_addc_u32 s65, s41, 0
    s_add_u32 s66, s64, 32768
    s_addc_u32 s67, s65, 0
    s_mul_i32 s3, s42, 0x01010101
    s_mov_b32 s15, 0x3fb8aa3b
    s_barrier
    s_branch L_BD_COMB
L_AM1:
    s_barrier
    s_mov_b64 exec, s[52:53]
    global_store_dwordx4 v33, v[28:31], s[62:63] sc1
    s_mov_b64 exec, -1
    s_lshl_b32 s8, s6, 8
    v_lshlrev_b32 v6, 4, v5
    v_lshl_add_u32 v6, v4, 13, v6
    v_add_u32 v6, s8, v6
    v_add_u32 v7, 0x1000, v6
    s_lshr_b32 s8, s6, 1
    s_lshl_b32 s8, s8, 10
    v_lshlrev_b32 v8, 4, v1
    v_add_u32 v8, s8, v8
    s_lshl_b32 s8, s6, 7
    s_add_u32 s8, s8, 132096
    v_lshlrev_b32 v9, 1, v4
    v_lshl_add_u32 v9, v5, 3, v9
    v_add_u32 v9, s8, v9
    s_lshl_b32 s8, s7, 8
    s_and_b32 s10, s6, 3
    s_lshl_b32 s10, s10, 6
    s_add_u32 s8, s8, s10
    v_lshlrev_b32 v19, 4, v4
    v_add_u32 v23, s8, v19
    v_add_u32 v18, 131072, v19
    v_mov_b32 v25, s42
    s_mov_b32 s13, 0xff
    s_mov_b32 s52, 0x00010001
    s_mov_b32 s53, s52
    s_lshl_b32 s12, s4, 11
    s_add_u32 s68, s12, 65536
    s_add_u32 s68, s40, s68
    s_addc_u32 s69, s41, 0
    s_lshl_b32 s12, s4, 15
    s_add_u32 s54, s12, 262144
    s_add_u32 s54, s40, s54
    s_addc_u32 s55, s41, 0
    s_add_u32 s56, s12, 524288
    s_add_u32 s56, s40, s56
    s_addc_u32 s57, s41, 0
    s_lshl_b32 s12, s4, 12
    s_add_u32 s64, s12, 917504
    s_add_u32 s64, s40, s64
    s_addc_u32 s65, s41, 0
    s_add_u32 s66, s64, 32768
    s_addc_u32 s67, s65, 0
    s_mul_i32 s3, s42, 0x01010101
    s_mov_b32 s15, 0x3fb8aa3b
    v_lshrrev_b32 v10, 3, v1
    v_and_b32 v11, 7, v1
    v_and_b32 v12, 2, v10
    v_xor_b32 v11, v11, v12
    v_lshlrev_b32 v11, 4, v11
    v_lshl_add_u32 v14, v10, 10, v11
    s_and_b32 s9, s6, 1
    s_lshl_b32 s9, s9, 6
    v_xor_b32 v14, s9, v14
    s_lshl_b32 s9, s7, 7
    s_lshl_b32 s11, s4, 19
    s_add_u32 s11, s11, s9
    s_sub_u32 s12, 0x400000, s11
    v_lshrrev_b32 v16, 2, v5
    v_and_b32 v17, 2, v16
    v_and_b32 v20, 1, v4
    v_lshl_or_b32 v17, v20, 2, v17
    v_bfe_u32 v20, v5, 1, 1
    s_lshl_b32 s8, s6, 1
    v_add_u32 v20, s8, v20
    v_xor_b32 v17, v17, v20
    v_lshl_add_u32 v16, v4, 3, v16
    v_lshlrev_b32 v16, 7, v16
    v_lshl_add_u32 v16, v17, 4, v16
    v_and_b32 v17, 1, v5
    v_lshl_add_u32 v16, v17, 3, v16
    v_add_u32 v17, 0, v16
    s_lshl_b32 s9, s6, 10
    s_add_u32 m0, s9, 0
    s_lshl_b32 s14, s6, 13
    s_add_u32 s48, s24, s11
    s_addc_u32 s49, s25, 0
    s_and_b32 s49, s49, 0xffff
    s_mov_b32 s50, s12
    s_mov_b32 s51, 0x20000
    s_lshr_b32 s10, 200, s7
    s_and_b32 s10, s10, 1
    s_lshl_b32 s10, s10, 2
    s_add_u32 s10, s10, 134976
    v_mov_b32 v20, s10
L_AM_GO:
    ds_read_b32 v21, v20 offset:4
    s_waitcnt lgkmcnt(0)
    v_cmp_gt_u32 vcc, 4, v21
    s_cbranch_vccz L_AM_GO2
    s_sleep 1
    s_branch L_AM_GO
L_AM_GO2:
    s_mov_b32 s11, 0
L_BD_REST:
    buffer_load_dwordx4 v14, s[48:51], s14 offen nt lds
    s_add_u32 m0, m0, 4096
    s_add_u32 s14, s14, 0x8000
    buffer_load_dwordx4 v14, s[48:51], s14 offen nt lds
    s_add_u32 m0, m0, 4096
    s_add_u32 s14, s14, 0x8000
    s_add_u32 s11, s11, 1
    s_cmp_lt_u32 s11, 8
    s_cbranch_scc1 L_BD_REST
L_BD_WODONE:
    s_waitcnt vmcnt(0)
    s_barrier
L_BD_COMB:
    global_load_dwordx4 v[48:51], v8, s[64:65] sc1
    global_load_dwordx4 v[32:35], v6, s[54:55] offset:0 sc1
    global_load_dwordx4 v[36:39], v6, s[54:55] offset:2048 sc1
    global_load_dwordx4 v[40:43], v7, s[54:55] offset:0 sc1
    global_load_dwordx4 v[44:47], v7, s[54:55] offset:2048 sc1
    s_mov_b32 s43, 0
    s_cmp_ge_u32 s6, 4
    s_cbranch_scc1 L_BD_NOTR
    ds_read_b64_tr_b16 v[64:65], v17 offset:0
    ds_read_b64_tr_b16 v[66:67], v17 offset:512
    ds_read_b64_tr_b16 v[68:69], v17 offset:4096
    ds_read_b64_tr_b16 v[70:71], v17 offset:4608
    ds_read_b64_tr_b16 v[72:73], v17 offset:8192
    ds_read_b64_tr_b16 v[74:75], v17 offset:8704
    ds_read_b64_tr_b16 v[76:77], v17 offset:12288
    ds_read_b64_tr_b16 v[78:79], v17 offset:12800
    ds_read_b64_tr_b16 v[80:81], v17 offset:16384
    ds_read_b64_tr_b16 v[82:83], v17 offset:16896
    ds_read_b64_tr_b16 v[84:85], v17 offset:20480
    ds_read_b64_tr_b16 v[86:87], v17 offset:20992
    ds_read_b64_tr_b16 v[88:89], v17 offset:24576
    ds_read_b64_tr_b16 v[90:91], v17 offset:25088
    ds_read_b64_tr_b16 v[92:93], v17 offset:28672
    ds_read_b64_tr_b16 v[94:95], v17 offset:29184
    ds_read_b64_tr_b16 v[96:97], v17 offset:32768
    ds_read_b64_tr_b16 v[98:99], v17 offset:33280
    ds_read_b64_tr_b16 v[100:101], v17 offset:36864
    ds_read_b64_tr_b16 v[102:103], v17 offset:37376
    ds_read_b64_tr_b16 v[104:105], v17 offset:40960
    ds_read_b64_tr_b16 v[106:107], v17 offset:41472
    ds_read_b64_tr_b16 v[108:109], v17 offset:45056
    ds_read_b64_tr_b16 v[110:111], v17 offset:45568
    ds_read_b64_tr_b16 v[112:113], v17 offset:49152
    ds_read_b64_tr_b16 v[114:115], v17 offset:49664
    ds_read_b64_tr_b16 v[116:117], v17 offset:53248
    ds_read_b64_tr_b16 v[118:119], v17 offset:53760
    ds_read_b64_tr_b16 v[120:121], v17 offset:57344
    ds_read_b64_tr_b16 v[122:123], v17 offset:57856
    ds_read_b64_tr_b16 v[124:125], v17 offset:61440
    ds_read_b64_tr_b16 v[126:127], v17 offset:61952
L_BD_NOTR:
    s_waitcnt vmcnt(0)
    v_xor_b32 v32, s42, v32
    v_xor_b32 v33, s42, v33
    v_xor_b32 v34, s42, v34
    v_xor_b32 v35, s42, v35
    v_or3_b32 v20, v32, v33, v34
    v_or_b32 v20, v20, v35
    v_and_b32 v20, 0xff, v20
    v_cmp_ne_u32 s[44:45], 0, v20
    v_xor_b32 v36, s42, v36
    v_xor_b32 v37, s42, v37
    v_xor_b32 v38, s42, v38
    v_xor_b32 v39, s42, v39
    v_or3_b32 v20, v36, v37, v38
    v_or_b32 v20, v20, v39
    v_and_b32 v20, 0xff, v20
    v_cmp_ne_u32 s[46:47], 0, v20
    v_xor_b32 v40, s42, v40
    v_xor_b32 v41, s42, v41
    v_xor_b32 v42, s42, v42
    v_xor_b32 v43, s42, v43
    v_or3_b32 v20, v40, v41, v42
    v_or_b32 v20, v20, v43
    v_and_b32 v20, 0xff, v20
    v_cmp_ne_u32 s[48:49], 0, v20
    v_xor_b32 v44, s42, v44
    v_xor_b32 v45, s42, v45
    v_xor_b32 v46, s42, v46
    v_xor_b32 v47, s42, v47
    v_or3_b32 v20, v44, v45, v46
    v_or_b32 v20, v20, v47
    v_and_b32 v20, 0xff, v20
    v_cmp_ne_u32 s[50:51], 0, v20
    v_cmp_ne_u32 vcc, s3, v50
    s_cbranch_vccz L_BD_AOK
    global_load_dwordx4 v[48:51], v8, s[64:65] sc1
L_BD_A1:
    s_waitcnt vmcnt(0)
    v_cmp_ne_u32 vcc, s3, v50
    s_bcnt1_i32_b64 s10, vcc
    s_cmp_le_u32 s10, 20
    s_cbranch_scc1 L_BD_MID
    global_load_dwordx4 v[48:51], v8, s[64:65] sc1
    s_add_u32 s43, s43, 1
    s_cmp_ge_u32 s43, 256
    s_cselect_b64 s[54:55], s[56:57], s[54:55]
    s_cselect_b64 s[64:65], s[66:67], s[64:65]
    s_cmp_lt_u32 s43, 1048576
    s_cbranch_scc1 L_BD_A1
L_BD_MID:
    s_cmp_eq_u32 s10, 0
    s_cbranch_scc1 L_BD_AOK
    s_mov_b64 exec, s[44:45]
    global_load_dwordx4 v[32:35], v6, s[54:55] offset:0 sc1
    s_mov_b64 exec, s[46:47]
    global_load_dwordx4 v[36:39], v6, s[54:55] offset:2048 sc1
    s_mov_b64 exec, s[48:49]
    global_load_dwordx4 v[40:43], v7, s[54:55] offset:0 sc1
    s_mov_b64 exec, s[50:51]
    global_load_dwordx4 v[44:47], v7, s[54:55] offset:2048 sc1
    s_mov_b64 exec, -1
    s_waitcnt vmcnt(0)
    global_load_dwordx4 v[48:51], v8, s[64:65] sc1
    s_mov_b64 exec, s[44:45]
    v_xor_b32 v32, s42, v32
    v_xor_b32 v33, s42, v33
    v_xor_b32 v34, s42, v34
    v_xor_b32 v35, s42, v35
    v_or3_b32 v20, v32, v33, v34
    v_or_b32 v20, v20, v35
    v_and_b32 v20, 0xff, v20
    v_cmp_ne_u32 s[44:45], 0, v20
    s_mov_b64 exec, s[46:47]
    v_xor_b32 v36, s42, v36
    v_xor_b32 v37, s42, v37
    v_xor_b32 v38, s42, v38
    v_xor_b32 v39, s42, v39
    v_or3_b32 v20, v36, v37, v38
    v_or_b32 v20, v20, v39
    v_and_b32 v20, 0xff, v20
    v_cmp_ne_u32 s[46:47], 0, v20
    s_mov_b64 exec, s[48:49]
    v_xor_b32 v40, s42, v40
    v_xor_b32 v41, s42, v41
    v_xor_b32 v42, s42, v42
    v_xor_b32 v43, s42, v43
    v_or3_b32 v20, v40, v41, v42
    v_or_b32 v20, v20, v43
    v_and_b32 v20, 0xff, v20
    v_cmp_ne_u32 s[48:49], 0, v20
    s_mov_b64 exec, s[50:51]
    v_xor_b32 v44, s42, v44
    v_xor_b32 v45, s42, v45
    v_xor_b32 v46, s42, v46
    v_xor_b32 v47, s42, v47
    v_or3_b32 v20, v44, v45, v46
    v_or_b32 v20, v20, v47
    v_and_b32 v20, 0xff, v20
    v_cmp_ne_u32 s[50:51], 0, v20
    s_mov_b64 exec, -1
L_BD_A2:
    s_waitcnt vmcnt(0)
    v_cmp_ne_u32 vcc, s3, v50
    s_bcnt1_i32_b64 s10, vcc
    s_cmp_le_u32 s10, 0
    s_cbranch_scc1 L_BD_AOK
    global_load_dwordx4 v[48:51], v8, s[64:65] sc1
    s_add_u32 s43, s43, 1
    s_cmp_ge_u32 s43, 256
    s_cselect_b64 s[54:55], s[56:57], s[54:55]
    s_cselect_b64 s[64:65], s[66:67], s[64:65]
    s_cmp_lt_u32 s43, 1048576
    s_cbranch_scc1 L_BD_A2
L_BD_AOK:
    s_mov_b64 exec, s[44:45]
    s_cbranch_execz L_bl_1
    global_load_dwordx4 v[32:35], v6, s[54:55] offset:0 sc1
L_bl_1:
    s_mov_b64 exec, s[46:47]
    s_cbranch_execz L_bl_2
    global_load_dwordx4 v[36:39], v6, s[54:55] offset:2048 sc1
L_bl_2:
    s_mov_b64 exec, s[48:49]
    s_cbranch_execz L_bl_3
    global_load_dwordx4 v[40:43], v7, s[54:55] offset:0 sc1
L_bl_3:
    s_mov_b64 exec, s[50:51]
    s_cbranch_execz L_bl_4
    global_load_dwordx4 v[44:47], v7, s[54:55] offset:2048 sc1
L_bl_4:
    s_mov_b64 exec, -1
    v_mov_b32 v20, v48
    s_nop 1
    v_max_f32_dpp v20, v20, v20 row_ror:1 row_mask:0xf bank_mask:0xf
    s_nop 1
    v_max_f32_dpp v20, v20, v20 row_ror:2 row_mask:0xf bank_mask:0xf
    s_nop 1
    v_max_f32_dpp v20, v20, v20 row_ror:4 row_mask:0xf bank_mask:0xf
    s_nop 1
    v_max_f32_dpp v20, v20, v20 row_ror:8 row_mask:0xf bank_mask:0xf
    v_mov_b32 v21, v49
    s_nop 1
    v_permlane16_swap_b32 v49, v21
    v_add_f32 v49, v49, v21
    v_mov_b32 v21, v49
    s_nop 1
    v_permlane32_swap_b32 v49, v21
    v_add_f32 v49, v49, v21
    v_sub_f32 v48, v48, v20
    v_mul_f32 v48, s15, v48
    v_exp_f32 v48, v48
    s_nop 0
    v_mul_f32 v49, v48, v49
    s_nop 1
    v_add_f32_dpp v49, v49, v49 row_ror:1 row_mask:0xf bank_mask:0xf
    s_nop 1
    v_add_f32_dpp v49, v49, v49 row_ror:2 row_mask:0xf bank_mask:0xf
    s_nop 1
    v_add_f32_dpp v49, v49, v49 row_ror:4 row_mask:0xf bank_mask:0xf
    s_nop 1
    v_add_f32_dpp v49, v49, v49 row_ror:8 row_mask:0xf bank_mask:0xf
    v_rcp_f32 v49, v49
    s_nop 0
    v_mul_f32 v48, v48, v49
    v_mov_b32 v49, v48
    s_nop 1
    v_mov_b32_dpp v49, v48 row_ror:12 row_mask:0x2 bank_mask:0xf
    v_mov_b32_dpp v49, v48 row_ror:8 row_mask:0x4 bank_mask:0xf
    v_mov_b32_dpp v49, v48 row_ror:4 row_mask:0x8 bank_mask:0xf
    s_nop 1
    v_mov_b32_dpp v52, v49 row_newbcast:0 row_mask:0xf bank_mask:0xf
    v_mov_b32_dpp v53, v49 row_newbcast:1 row_mask:0xf bank_mask:0xf
    v_mov_b32_dpp v54, v49 row_newbcast:2 row_mask:0xf bank_mask:0xf
    v_mov_b32_dpp v55, v49 row_newbcast:3 row_mask:0xf bank_mask:0xf
    s_or_b64 vcc, s[44:45], s[46:47]
    s_or_b64 vcc, vcc, s[48:49]
    s_or_b64 vcc, vcc, s[50:51]
    s_cbranch_scc0 L_pmok_6
    s_waitcnt vmcnt(0)
    s_branch L_pmck_7
L_pm_5:
    s_mov_b64 exec, s[44:45]
    s_cbranch_execz L_sl_8
    global_load_dwordx4 v[32:35], v6, s[54:55] offset:0 sc1
L_sl_8:
    s_mov_b64 exec, s[46:47]
    s_cbranch_execz L_sl_9
    global_load_dwordx4 v[36:39], v6, s[54:55] offset:2048 sc1
L_sl_9:
    s_mov_b64 exec, s[48:49]
    s_cbranch_execz L_sl_10
    global_load_dwordx4 v[40:43], v7, s[54:55] offset:0 sc1
L_sl_10:
    s_mov_b64 exec, s[50:51]
    s_cbranch_execz L_sl_11
    global_load_dwordx4 v[44:47], v7, s[54:55] offset:2048 sc1
L_sl_11:
    s_waitcnt vmcnt(0)
L_pmck_7:
    s_mov_b64 exec, s[44:45]
    s_cbranch_execz L_sk_12
    v_xor_b32 v32, s42, v32
    v_xor_b32 v33, s42, v33
    v_xor_b32 v34, s42, v34
    v_xor_b32 v35, s42, v35
    v_or3_b32 v20, v32, v33, v34
    v_or_b32 v20, v20, v35
    v_and_b32 v20, 0xff, v20
    v_cmp_ne_u32 s[44:45], 0, v20
L_sk_12:
    s_mov_b64 exec, s[46:47]
    s_cbranch_execz L_sk_13
    v_xor_b32 v36, s42, v36
    v_xor_b32 v37, s42, v37
    v_xor_b32 v38, s42, v38
    v_xor_b32 v39, s42, v39
    v_or3_b32 v20, v36, v37, v38
    v_or_b32 v20, v20, v39
    v_and_b32 v20, 0xff, v20
    v_cmp_ne_u32 s[46:47], 0, v20
L_sk_13:
    s_mov_b64 exec, s[48:49]
    s_cbranch_execz L_sk_14
    v_xor_b32 v40, s42, v40
    v_xor_b32 v41, s42, v41
    v_xor_b32 v42, s42, v42
    v_xor_b32 v43, s42, v43
    v_or3_b32 v20, v40, v41, v42
    v_or_b32 v20, v20, v43
    v_and_b32 v20, 0xff, v20
    v_cmp_ne_u32 s[48:49], 0, v20
L_sk_14:
    s_mov_b64 exec, s[50:51]
    s_cbranch_execz L_sk_15
    v_xor_b32 v44, s42, v44
    v_xor_b32 v45, s42, v45
    v_xor_b32 v46, s42, v46
    v_xor_b32 v47, s42, v47
    v_or3_b32 v20, v44, v45, v46
    v_or_b32 v20, v20, v47
    v_and_b32 v20, 0xff, v20
    v_cmp_ne_u32 s[50:51], 0, v20
L_sk_15:
    s_or_b64 vcc, s[44:45], s[46:47]
    s_or_b64 vcc, vcc, s[48:49]
    s_or_b64 vcc, vcc, s[50:51]
    s_cbranch_scc0 L_pmok_6
    s_add_u32 s43, s43, 1
    s_cmp_ge_u32 s43, 256
    s_cselect_b64 s[54:55], s[56:57], s[54:55]
    s_cmp_lt_u32 s43, 1048576
    s_cbranch_scc1 L_pm_5
L_pmok_6:
    s_mov_b64 exec, -1
    v_mul_f32 v32, v52, v32
    v_mul_f32 v33, v52, v33
    v_mul_f32 v34, v52, v34
    v_mul_f32 v35, v52, v35
    v_fmac_f32 v32, v53, v36
    v_fmac_f32 v33, v53, v37
    v_fmac_f32 v34, v53, v38
    v_fmac_f32 v35, v53, v39
    v_fmac_f32 v32, v54, v40
    v_fmac_f32 v33, v54, v41
    v_fmac_f32 v34, v54, v42
    v_fmac_f32 v35, v54, v43
    v_fmac_f32 v32, v55, v44
    v_fmac_f32 v33, v55, v45
    v_fmac_f32 v34, v55, v46
    v_fmac_f32 v35, v55, v47
    s_nop 1
    v_permlane32_swap_b32 v32, v34
    v_permlane32_swap_b32 v33, v35
    v_add_f32 v32, v32, v34
    v_add_f32 v33, v33, v35
    s_nop 1
    v_permlane16_swap_b32 v32, v33
    v_add_f32 v32, v32, v33
    v_cvt_pk_bf16_f32 v32, 0, v32
    ds_write_b16_d16_hi v9, v32
    s_waitcnt lgkmcnt(0)
    s_barrier
    s_cmp_ge_u32 s6, 4
    s_cbranch_scc1 L_BD_end
    ds_read_b128 v[128:131], v18 offset:1024
    ds_read_b128 v[132:135], v18 offset:1088
    ds_read_b128 v[136:139], v18 offset:1152
    ds_read_b128 v[140:143], v18 offset:1216
    ds_read_b128 v[144:147], v18 offset:1280
    ds_read_b128 v[148:151], v18 offset:1344
    ds_read_b128 v[152:155], v18 offset:1408
    ds_read_b128 v[156:159], v18 offset:1472
    s_waitcnt lgkmcnt(7)
    v_mfma_f32_16x16x32_bf16 v[28:31], v[64:67], v[128:131], 0
    ds_read_b128 v[128:131], v18 offset:1536
    s_waitcnt lgkmcnt(7)
    v_mfma_f32_16x16x32_bf16 v[28:31], v[68:71], v[132:135], v[28:31]
    ds_read_b128 v[132:135], v18 offset:1600
    s_waitcnt lgkmcnt(7)
    v_mfma_f32_16x16x32_bf16 v[28:31], v[72:75], v[136:139], v[28:31]
    ds_read_b128 v[136:139], v18 offset:1664
    s_waitcnt lgkmcnt(7)
    v_mfma_f32_16x16x32_bf16 v[28:31], v[76:79], v[140:143], v[28:31]
    ds_read_b128 v[140:143], v18 offset:1728
    s_waitcnt lgkmcnt(7)
    v_mfma_f32_16x16x32_bf16 v[28:31], v[80:83], v[144:147], v[28:31]
    ds_read_b128 v[144:147], v18 offset:1792
    s_waitcnt lgkmcnt(7)
    v_mfma_f32_16x16x32_bf16 v[28:31], v[84:87], v[148:151], v[28:31]
    ds_read_b128 v[148:151], v18 offset:1856
    s_waitcnt lgkmcnt(7)
    v_mfma_f32_16x16x32_bf16 v[28:31], v[88:91], v[152:155], v[28:31]
    ds_read_b128 v[152:155], v18 offset:1920
    s_waitcnt lgkmcnt(7)
    v_mfma_f32_16x16x32_bf16 v[28:31], v[92:95], v[156:159], v[28:31]
    ds_read_b128 v[156:159], v18 offset:1984
    s_waitcnt lgkmcnt(7)
    v_mfma_f32_16x16x32_bf16 v[28:31], v[96:99], v[128:131], v[28:31]
    s_waitcnt lgkmcnt(6)
    v_mfma_f32_16x16x32_bf16 v[28:31], v[100:103], v[132:135], v[28:31]
    s_waitcnt lgkmcnt(5)
    v_mfma_f32_16x16x32_bf16 v[28:31], v[104:107], v[136:139], v[28:31]
    s_waitcnt lgkmcnt(4)
    v_mfma_f32_16x16x32_bf16 v[28:31], v[108:111], v[140:143], v[28:31]
    s_waitcnt lgkmcnt(3)
    v_mfma_f32_16x16x32_bf16 v[28:31], v[112:115], v[144:147], v[28:31]
    s_waitcnt lgkmcnt(2)
    v_mfma_f32_16x16x32_bf16 v[28:31], v[116:119], v[148:151], v[28:31]
    s_waitcnt lgkmcnt(1)
    v_mfma_f32_16x16x32_bf16 v[28:31], v[120:123], v[152:155], v[28:31]
    s_waitcnt lgkmcnt(0)
    v_mfma_f32_16x16x32_bf16 v[28:31], v[124:127], v[156:159], v[28:31]
    s_lshl_b32 s8, s6, 6
    v_add_u32 v22, s8, v18
    v_lshlrev_b32 v23, 4, v1
    v_add_u32 v21, 131072, v23
    s_lshl_b32 s8, s7, 8
    v_add_u32 v23, s8, v23
    s_nop 1
    v_bfi_b32 v28, s13, v25, v28
    v_bfi_b32 v29, s13, v25, v29
    v_bfi_b32 v30, s13, v25, v30
    v_bfi_b32 v31, s13, v25, v31
    s_mov_b64 exec, s[52:53]
    ds_write_b128 v22, v[28:31]
    s_mov_b64 exec, 0xffff
    s_waitcnt lgkmcnt(0)
    s_barrier
    s_cmp_lg_u32 s6, 0
    s_cbranch_scc1 L_BD_end
    ds_read_b128 v[28:31], v21
    s_waitcnt lgkmcnt(0)
    global_store_dwordx4 v23, v[28:31], s[68:69] sc1
L_BD_end:
    s_endpgm
L_ATT1:
    v_xor_b32 v12, v4, v5
    v_lshlrev_b32 v12, 4, v12
    v_lshl_add_u32 v12, v5, 8, v12
    v_add_u32 v12, s9, v12
    v_xor_b32 v13, 64, v12
    v_xor_b32 v14, 0x80, v12
    v_xor_b32 v15, 0xc0, v12
    v_and_b32 v16, 3, v5
    v_mul_u32_u24 v17, 320, v16
    v_lshl_add_u32 v17, v4, 4, v17
    v_add_u32 v17, 131072, v17
    s_mov_b32 s52, 0x000f000f
    s_mov_b32 s53, s52
    s_lshl_b64 s[54:55], s[52:53], 4
    s_lshl_b64 s[56:57], s[52:53], 8
    s_lshl_b64 s[58:59], s[52:53], 12
    v_lshlrev_b32 v21, 6, v4
    v_lshl_add_u32 v21, v16, 4, v21
    v_add_u32 v21, 133120, v21
    v_lshrrev_b32 v20, 3, v5
    s_lshl_b32 s12, s6, 1
    v_add_u32 v20, s12, v20
    v_lshl_add_u32 v20, v20, 8, v21
    v_bfe_u32 v22, v5, 2, 1
    v_lshl_add_u32 v20, v22, 3, v20
    v_lshlrev_b32 v23, 2, v16
    v_add_u32 v23, 132352, v23
    v_lshlrev_b32 v34, 3, v5
    v_lshl_add_u32 v34, v4, 1, v34
    s_mul_i32 s12, s6, 320
    s_add_u32 s12, s12, 131072
    v_add_u32 v34, s12, v34
    s_lshl_b32 s12, s4, 12
    s_lshl_b32 s10, s6, 8
    s_add_u32 s12, s12, s10
    s_lshl_b32 s10, s5, 4
    s_add_u32 s12, s12, s10
    s_add_u32 s60, s12, 917504
    s_add_u32 s60, s40, s60
    s_addc_u32 s61, s41, 0
    s_add_u32 s62, s60, 32768
    s_addc_u32 s63, s61, 0
    v_lshlrev_b32 v26, 10, v1
    v_mov_b32 v25, s42
    s_mul_i32 s12, s42, 0x01010101
    v_mov_b32 v38, s12
    v_mov_b32 v39, s12
    s_mov_b32 s14, 0x3db504f3
    s_mov_b32 s15, 0x3fb8aa3b
    s_waitcnt vmcnt(17)
    ds_read_b128 v[64:67], v12 offset:0
    ds_read_b128 v[68:71], v13 offset:0
    ds_read_b128 v[72:75], v14 offset:0
    ds_read_b128 v[76:79], v15 offset:0
    ds_read_b128 v[80:83], v12 offset:4096
    ds_read_b128 v[84:87], v13 offset:4096
    ds_read_b128 v[88:91], v14 offset:4096
    ds_read_b128 v[92:95], v15 offset:4096
    ds_read_b128 v[96:99], v12 offset:8192
    ds_read_b128 v[100:103], v13 offset:8192
    ds_read_b128 v[104:107], v14 offset:8192
    ds_read_b128 v[108:111], v15 offset:8192
    ds_read_b128 v[112:115], v12 offset:12288
    ds_read_b128 v[116:119], v13 offset:12288
    ds_read_b128 v[120:123], v14 offset:12288
    ds_read_b128 v[124:127], v15 offset:12288
    s_waitcnt vmcnt(9)
    s_barrier
    s_waitcnt vmcnt(2)
    s_mov_b32 s43, 0
L_poll_21:
    global_load_dwordx4 v[40:43], v32, s[68:69] offset:0 sc1
    global_load_dwordx4 v[44:47], v33, s[68:69] offset:0 sc1
    global_load_dwordx4 v[48:51], v32, s[68:69] offset:256 sc1
    global_load_dwordx4 v[52:55], v33, s[68:69] offset:256 sc1
    s_waitcnt vmcnt(0)
    v_xor_b32 v40, s42, v40
    v_xor_b32 v41, s42, v41
    v_xor_b32 v42, s42, v42
    v_xor_b32 v43, s42, v43
    v_xor_b32 v44, s42, v44
    v_xor_b32 v45, s42, v45
    v_xor_b32 v46, s42, v46
    v_xor_b32 v47, s42, v47
    v_xor_b32 v48, s42, v48
    v_xor_b32 v49, s42, v49
    v_xor_b32 v50, s42, v50
    v_xor_b32 v51, s42, v51
    v_xor_b32 v52, s42, v52
    v_xor_b32 v53, s42, v53
    v_xor_b32 v54, s42, v54
    v_xor_b32 v55, s42, v55
    v_or3_b32 v35, v40, v41, v42
    v_or3_b32 v35, v35, v43, v44
    v_or3_b32 v35, v35, v45, v46
    v_or3_b32 v35, v35, v47, v48
    v_or3_b32 v35, v35, v49, v50
    v_or3_b32 v35, v35, v51, v52
    v_or3_b32 v35, v35, v53, v54
    v_or_b32 v35, v35, v55
    v_and_b32 v35, 0xff, v35
    v_cmp_ne_u32 vcc, 0, v35
    s_cbranch_vccz L_ok_22
    s_mov_b64 exec, vcc
    s_add_u32 s43, s43, 1
    s_cmp_lt_u32 s43, 1048576
    s_cbranch_scc1 L_poll_21
L_ok_22:
    s_mov_b64 exec, -1
    v_add_f32 v40, v40, v44
    v_add_f32 v41, v41, v45
    v_add_f32 v42, v42, v46
    v_add_f32 v43, v43, v47
    v_add_f32 v48, v48, v52
    v_add_f32 v49, v49, v53
    v_add_f32 v50, v50, v54
    v_add_f32 v51, v51, v55
    v_permlane32_swap_b32 v40, v42
    v_permlane32_swap_b32 v41, v43
    s_nop 0
    v_permlane32_swap_b32 v48, v50
    v_permlane32_swap_b32 v49, v51
    v_add_f32 v40, v40, v42
    v_add_f32 v41, v41, v43
    v_add_f32 v48, v48, v50
    v_add_f32 v49, v49, v51
    s_nop 0
    v_permlane16_swap_b32 v40, v41
    v_permlane16_swap_b32 v48, v49
    v_add_f32 v40, v40, v41
    v_add_f32 v48, v48, v49
    v_cvt_pk_bf16_f32 v40, v40, v48
    ds_write_b16 v34, v40
    ds_write_b16_d16_hi v34, v40 offset:128
    s_waitcnt lgkmcnt(0)
    s_barrier
    ds_read_b128 v[128:131], v17 offset:0
    ds_read_b128 v[132:135], v17 offset:64
    ds_read_b128 v[136:139], v17 offset:128
    ds_read_b128 v[140:143], v17 offset:192
    s_waitcnt lgkmcnt(3)
    v_mfma_f32_16x16x32_bf16 v[144:147], v[64:67], v[128:131], 0
    v_mfma_f32_16x16x32_bf16 v[148:151], v[80:83], v[128:131], 0
    s_waitcnt lgkmcnt(2)
    v_mfma_f32_16x16x32_bf16 v[144:147], v[68:71], v[132:135], v[144:147]
    v_mfma_f32_16x16x32_bf16 v[148:151], v[84:87], v[132:135], v[148:151]
    s_waitcnt lgkmcnt(1)
    v_mfma_f32_16x16x32_bf16 v[144:147], v[72:75], v[136:139], v[144:147]
    v_mfma_f32_16x16x32_bf16 v[148:151], v[88:91], v[136:139], v[148:151]
    s_waitcnt lgkmcnt(0)
    v_mfma_f32_16x16x32_bf16 v[144:147], v[76:79], v[140:143], v[144:147]
    v_mfma_f32_16x16x32_bf16 v[148:151], v[92:95], v[140:143], v[148:151]
    v_mfma_f32_16x16x32_bf16 v[152:155], v[96:99], v[128:131], 0
    v_mfma_f32_16x16x32_bf16 v[152:155], v[100:103], v[132:135], v[152:155]
    v_mfma_f32_16x16x32_bf16 v[152:155], v[104:107], v[136:139], v[152:155]
    v_mfma_f32_16x16x32_bf16 v[152:155], v[108:111], v[140:143], v[152:155]
    v_mfma_f32_16x16x32_bf16 v[156:159], v[112:115], v[128:131], 0
    v_mfma_f32_16x16x32_bf16 v[156:159], v[116:119], v[132:135], v[156:159]
    v_mfma_f32_16x16x32_bf16 v[156:159], v[120:123], v[136:139], v[156:159]
    s_nop 0
    v_cndmask_b32 v28, v144, v148, s[54:55]
    v_cndmask_b32 v29, v145, v149, s[54:55]
    v_mfma_f32_16x16x32_bf16 v[156:159], v[124:127], v[140:143], v[156:159]
    v_cndmask_b32 v30, v146, v150, s[54:55]
    v_cndmask_b32 v31, v147, v151, s[54:55]
    v_cndmask_b32 v28, v28, v152, s[56:57]
    v_cndmask_b32 v29, v29, v153, s[56:57]
    v_cndmask_b32 v30, v30, v154, s[56:57]
    v_cndmask_b32 v31, v31, v155, s[56:57]
    s_nop 1
    v_cndmask_b32 v28, v28, v156, s[58:59]
    v_cndmask_b32 v29, v29, v157, s[58:59]
    v_cndmask_b32 v30, v30, v158, s[58:59]
    v_cndmask_b32 v31, v31, v159, s[58:59]
    v_cvt_pk_bf16_f32 v28, 0, v28
    v_cvt_pk_bf16_f32 v29, 0, v29
    v_cvt_pk_bf16_f32 v30, 0, v30
    v_cvt_pk_bf16_f32 v31, 0, v31
    v_mul_f32 v28, s14, v28
    v_mul_f32 v29, s14, v29
    v_mul_f32 v30, s14, v30
    v_mul_f32 v31, s14, v31
    v_cvt_pk_bf16_f32 v28, 0, v28
    v_cvt_pk_bf16_f32 v29, 0, v29
    v_cvt_pk_bf16_f32 v30, 0, v30
    v_cvt_pk_bf16_f32 v31, 0, v31
    v_max3_f32 v32, v28, v29, v30
    v_max_f32 v32, v32, v31
    s_nop 1
    v_max_f32_dpp v32, v32, v32 row_ror:4 row_mask:0xf bank_mask:0xf
    s_nop 1
    v_max_f32_dpp v32, v32, v32 row_ror:8 row_mask:0xf bank_mask:0xf
    s_mov_b64 exec, s[52:53]
    ds_max_f32 v23, v32
    s_mov_b64 exec, -1
    v_mul_f32 v28, s15, v28
    v_mul_f32 v29, s15, v29
    v_mul_f32 v30, s15, v30
    v_mul_f32 v31, s15, v31
    s_waitcnt lgkmcnt(0)
    s_barrier
    ds_read_b32 v36, v23
    s_waitcnt lgkmcnt(0)
    v_fma_f32 v28, -v36, s15, v28
    v_fma_f32 v29, -v36, s15, v29
    v_fma_f32 v30, -v36, s15, v30
    v_fma_f32 v31, -v36, s15, v31
    v_exp_f32 v28, v28
    v_exp_f32 v29, v29
    v_exp_f32 v30, v30
    v_exp_f32 v31, v31
    s_nop 0
    v_cvt_pk_bf16_f32 v34, v28, v29
    v_cvt_pk_bf16_f32 v35, v30, v31
    ds_write_b64 v20, v[34:35]
    v_add_f32 v37, v28, v29
    v_add_f32 v33, v30, v31
    v_add_f32 v37, v37, v33
    s_waitcnt lgkmcnt(0)
    s_barrier
    s_nop 1
    v_add_f32_dpp v37, v37, v37 row_ror:4 row_mask:0xf bank_mask:0xf
    s_nop 1
    v_add_f32_dpp v37, v37, v37 row_ror:8 row_mask:0xf bank_mask:0xf
    v_mov_b32 v33, v37
    s_nop 1
    v_permlane16_swap_b32 v37, v33
    v_add_f32 v37, v37, v33
    v_mov_b32 v33, v37
    s_nop 1
    v_permlane32_swap_b32 v37, v33
    v_add_f32 v37, v37, v33
    s_mov_b64 exec, 15
    global_store_dwordx4 v26, v[36:39], s[60:61]
    s_barrier
    global_store_dwordx4 v26, v[36:39], s[62:63] sc1
    s_mov_b64 exec, -1
    s_cmp_lg_u32 s6, 0
    s_cbranch_scc1 L_ATT_end
    s_cmp_ge_u32 s5, 8
    s_cbranch_scc1 L_ATT_end
    s_lshl_b32 s7, s4, 3
    s_add_u32 s7, s7, s5
    s_mov_b32 s52, 0xffff0000
    s_mov_b32 s53, 0
    s_mov_b32 s54, 0
    s_mov_b32 s55, 0x0000ffff
    s_mov_b32 s56, 0
    s_mov_b32 s57, 0xffff0000
    v_and_b32 v6, 1, v1
    v_bfe_u32 v7, v1, 1, 3
    s_lshl_b32 s8, s7, 1
    v_add_u32 v8, s8, v6
    v_lshlrev_b32 v8, 4, v8
    v_lshl_add_u32 v9, v7, 11, v8
    v_lshrrev_b32 v10, 2, v8
    v_add_u32 v10, v10, v4
    v_lshlrev_b32 v10, 1, v10
    global_load_ushort v11, v10, s[16:17]
    s_add_u32 s60, s40, 98304
    s_addc_u32 s61, s41, 0
    s_add_u32 s62, s40, 104448
    s_addc_u32 s63, s41, 0
    s_add_u32 s64, s40, 65536
    s_addc_u32 s65, s41, 0
    s_add_u32 s66, s40, 106496
    s_addc_u32 s67, s41, 0
    s_add_u32 s68, s40, 112640
    s_addc_u32 s69, s41, 0
    s_mul_i32 s8, s7, 1792
    s_add_u32 s44, s8, 131072
    s_add_u32 s44, s40, s44
    s_addc_u32 s45, s41, 0
    v_lshlrev_b32 v29, 4, v1
    v_mov_b32 v44, 0
    v_mov_b32 v45, 0
    v_mov_b32 v46, 0
    v_mov_b32 v47, 0
    global_load_dwordx4 v[40:43], v29, s[44:45] sc1
    global_load_dwordx4 v[40:43], v29, s[44:45] offset:768 sc1
    s_mov_b32 s43, 0
L_poll_23:
    global_load_dwordx4 v[12:15], v8, s[60:61] sc1
    global_load_dwordx4 v[16:19], v8, s[62:63] sc1
    global_load_dwordx4 v[32:35], v8, s[66:67] sc1
    global_load_dwordx4 v[36:39], v8, s[68:69] sc1
    global_load_dwordx4 v[20:23], v9, s[64:65] sc1
    s_waitcnt vmcnt(0)
    v_xor_b32 v12, s42, v12
    v_xor_b32 v13, s42, v13
    v_xor_b32 v14, s42, v14
    v_xor_b32 v15, s42, v15
    v_xor_b32 v16, s42, v16
    v_xor_b32 v17, s42, v17
    v_xor_b32 v18, s42, v18
    v_xor_b32 v19, s42, v19
    v_xor_b32 v32, s42, v32
    v_xor_b32 v33, s42, v33
    v_xor_b32 v34, s42, v34
    v_xor_b32 v35, s42, v35
    v_xor_b32 v36, s42, v36
    v_xor_b32 v37, s42, v37
    v_xor_b32 v38, s42, v38
    v_xor_b32 v39, s42, v39
    v_xor_b32 v20, s42, v20
    v_xor_b32 v21, s42, v21
    v_xor_b32 v22, s42, v22
    v_xor_b32 v23, s42, v23
    v_or3_b32 v26, v12, v13, v14
    v_or3_b32 v26, v26, v15, v16
    v_or3_b32 v26, v26, v17, v18
    v_or3_b32 v26, v26, v19, v32
    v_or3_b32 v26, v26, v33, v34
    v_or3_b32 v26, v26, v35, v36
    v_or3_b32 v26, v26, v37, v38
    v_or3_b32 v26, v26, v39, v20
    v_or3_b32 v26, v26, v21, v22
    v_or_b32 v26, v26, v23
    v_and_b32 v26, 0xff, v26
    v_cmp_ne_u32 vcc, 0, v26
    s_cbranch_vccz L_ok_24
    s_mov_b64 exec, vcc
    s_add_u32 s43, s43, 1
    s_cmp_lt_u32 s43, 1048576
    s_cbranch_scc1 L_poll_23
L_ok_24:
    s_mov_b64 exec, -1
    v_cndmask_b32 v12, v12, v13, s[52:53]
    v_cndmask_b32 v12, v12, v14, s[54:55]
    v_cndmask_b32 v12, v12, v15, s[56:57]
    v_cndmask_b32 v16, v16, v17, s[52:53]
    v_cndmask_b32 v16, v16, v18, s[54:55]
    v_cndmask_b32 v16, v16, v19, s[56:57]
    v_cndmask_b32 v32, v32, v33, s[52:53]
    v_cndmask_b32 v32, v32, v34, s[54:55]
    v_cndmask_b32 v32, v32, v35, s[56:57]
    v_cndmask_b32 v36, v36, v37, s[52:53]
    v_cndmask_b32 v36, v36, v38, s[54:55]
    v_cndmask_b32 v36, v36, v39, s[56:57]
    v_cndmask_b32 v20, v20, v21, s[52:53]
    v_cndmask_b32 v20, v20, v22, s[54:55]
    v_cndmask_b32 v20, v20, v23, s[56:57]
    v_add_f32 v12, v12, v32
    v_add_f32 v16, v16, v36
    s_nop 1
    v_add_f32_dpp v20, v20, v20 row_ror:2 row_mask:0xf bank_mask:0xf
    s_nop 1
    v_add_f32_dpp v20, v20, v20 row_ror:4 row_mask:0xf bank_mask:0xf
    s_nop 1
    v_add_f32_dpp v20, v20, v20 row_ror:8 row_mask:0xf bank_mask:0xf
    v_cvt_pk_bf16_f32 v12, 0, v12
    v_cvt_pk_bf16_f32 v16, 0, v16
    v_lshlrev_b32 v11, 16, v11
    v_cvt_pk_bf16_f32 v20, 0, v20
    v_mul_f32 v20, v12, v20
    v_cvt_pk_bf16_f32 v20, 0, v20
    v_add_f32 v20, v11, v20
    v_cvt_pk_bf16_f32 v11, 0, v20
    v_add_u32 v30, 0x400, v29
    v_cndmask_b32 v30, v30, v29, s[56:57]
    v_mov_b32 v31, 1.0
    v_cndmask_b32 v31, v31, 0, s[56:57]
    s_mov_b32 s43, 0
L_poll_25:
    global_load_dwordx4 v[40:43], v29, s[44:45] sc1
    global_load_dwordx4 v[44:47], v30, s[44:45] sc1
    s_waitcnt vmcnt(0)
    v_xor_b32 v40, s42, v40
    v_xor_b32 v41, s42, v41
    v_xor_b32 v42, s42, v42
    v_xor_b32 v43, s42, v43
    v_xor_b32 v44, s42, v44
    v_xor_b32 v45, s42, v45
    v_xor_b32 v46, s42, v46
    v_xor_b32 v47, s42, v47
    v_or3_b32 v26, v40, v41, v42
    v_or3_b32 v26, v26, v43, v44
    v_or3_b32 v26, v26, v45, v46
    v_or_b32 v26, v26, v47
    v_and_b32 v26, 0xff, v26
    v_cmp_ne_u32 vcc, 0, v26
    s_cbranch_vccz L_ok_26
    s_mov_b64 exec, vcc
    s_add_u32 s43, s43, 1
    s_cmp_lt_u32 s43, 1048576
    s_cbranch_scc1 L_poll_25
L_ok_26:
    s_mov_b64 exec, -1
    v_fmac_f32 v40, v31, v44
    v_fmac_f32 v41, v31, v45
    v_fmac_f32 v42, v31, v46
    v_fmac_f32 v43, v31, v47
    s_nop 1
    v_permlane32_swap_b32 v40, v42
    v_permlane32_swap_b32 v41, v43
    v_add_f32 v40, v40, v42
    v_add_f32 v41, v41, v43
    s_nop 1
    v_permlane16_swap_b32 v40, v41
    v_add_f32 v40, v40, v41
    s_nop 1
    v_add_f32_dpp v40, v40, v40 row_ror:2 row_mask:0xf bank_mask:0xf
    s_nop 1
    v_add_f32_dpp v40, v40, v40 row_ror:4 row_mask:0xf bank_mask:0xf
    s_nop 1
    v_add_f32_dpp v40, v40, v40 row_ror:8 row_mask:0xf bank_mask:0xf
    v_cvt_pk_bf16_f32 v40, 0, v40
    v_mul_f32 v40, v16, v40
    v_cvt_pk_bf16_f32 v40, 0, v40
    v_add_f32 v40, v11, v40
    v_cvt_pk_bf16_f32 v40, 0, v40
    s_mov_b32 s52, 0x00030003
    s_mov_b32 s53, s52
    s_mov_b64 exec, s[52:53]
    global_store_short_d16_hi v10, v40, s[38:39]
    s_cmp_lg_u32 s7, 0
    s_cbranch_scc1 L_ATT_end
    s_mov_b64 exec, 1
    v_mov_b32 v2, 0
    global_store_dword v2, v25, s[40:41]
L_ATT_end:
    s_endpgm
L_AM_H_MOD:
    s_sub_u32 s12, s6, 4
    v_lshrrev_b32 v14, 2, v5
    v_lshl_add_u32 v14, v4, 3, v14
    v_and_b32 v16, 3, v5
    v_lshlrev_b32 v7, 3, v16
    s_lshr_b32 s10, s12, 1
    s_lshl_b32 s10, s10, 5
    s_and_b32 s11, s6, 1
    s_lshl_b32 s11, s11, 2
    s_add_u32 s10, s10, s11
    v_add_u32 v7, s10, v7
    v_lshrrev_b32 v17, 2, v5
    v_and_b32 v18, 1, v4
    v_lshl_or_b32 v17, v18, 2, v17
    v_xor_b32 v7, v7, v17
    v_lshrrev_b32 v17, 1, v16
    v_lshlrev_b32 v17, 3, v17
    v_xor_b32 v7, v7, v17
    v_lshlrev_b32 v7, 4, v7
    v_and_b32 v17, 1, v5
    v_lshl_add_u32 v7, v17, 3, v7
    v_lshl_add_u32 v7, v14, 10, v7
    v_add_u32 v7, 65536, v7
    v_mov_b32 v192, 0
    v_mov_b32 v193, 0
    v_mov_b32 v194, 0
    v_mov_b32 v195, 0
    v_mov_b32 v196, 0
    v_mov_b32 v197, 0
    v_mov_b32 v198, 0
    v_mov_b32 v199, 0
    v_mov_b32 v200, 0
    v_mov_b32 v201, 0
    v_mov_b32 v202, 0
    v_mov_b32 v203, 0
    v_mov_b32 v204, 0
    v_mov_b32 v205, 0
    v_mov_b32 v206, 0
    v_mov_b32 v207, 0
    v_mov_b32 v208, 0
    v_mov_b32 v209, 0
    v_mov_b32 v210, 0
    v_mov_b32 v211, 0
    v_mov_b32 v212, 0
    v_mov_b32 v213, 0
    v_mov_b32 v214, 0
    v_mov_b32 v215, 0
    v_mov_b32 v216, 0
    v_mov_b32 v217, 0
    v_mov_b32 v218, 0
    v_mov_b32 v219, 0
    v_mov_b32 v220, 0
    v_mov_b32 v221, 0
    v_mov_b32 v222, 0
    v_mov_b32 v223, 0
    v_mov_b32 v20, 134976
L_BM_W4:
    ds_read_b32 v21, v20
    s_waitcnt lgkmcnt(0)
    v_cmp_gt_u32 vcc, 4, v21
    s_cbranch_vccz L_AM_MLP
    s_sleep 4
    s_branch L_BM_W4
L_AM_NSP:
    v_lshrrev_b32 v14, 3, v1
    v_and_b32 v15, 7, v1
    v_bfe_u32 v16, v1, 4, 1
    v_xor_b32 v15, v15, v16
    v_mul_u32_u24 v6, 3584, v14
    v_lshl_add_u32 v6, v15, 4, v6
    v_xor_b32 v7, 32, v6
    v_xor_b32 v8, 64, v6
    v_xor_b32 v9, 0x60, v6
    v_lshlrev_b32 v10, 3, v16
    v_xor_b32 v10, v1, v10
    s_and_b32 s10, s6, 1
    s_lshl_b32 s10, s10, 2
    v_xor_b32 v10, s10, v10
    v_lshlrev_b32 v10, 4, v10
    v_xor_b32 v11, 16, v10
    v_xor_b32 v12, 32, v10
    v_xor_b32 v13, 48, v10
    s_lshr_b32 s10, s9, 1
    s_lshl_b32 s10, s10, 7
    s_sub_u32 s11, 1835008, s10
    s_add_u32 s44, s28, s10
    s_addc_u32 s45, s29, 0
    s_and_b32 s45, s45, 0xffff
    s_mov_b32 s46, s11
    s_mov_b32 s47, 0x20000
    s_add_u32 s48, s30, s10
    s_addc_u32 s49, s31, 0
    s_and_b32 s49, s49, 0xffff
    s_mov_b32 s50, s11
    s_mov_b32 s51, 0x20000
    s_and_b32 s3, s9, 1
    s_lshl_b32 s12, s3, 2
    s_add_u32 s12, s12, s6
    s_mul_i32 s12, s12, 229376
    s_lshl_b32 s13, s6, 13
    s_add_u32 s14, s13, 0
    s_add_u32 s15, s13, 32768
    s_mov_b32 s11, 0
L_AM_GU:
    s_mov_b32 m0, s14
    s_add_u32 s14, s14, 1024
    buffer_load_dwordx4 v6, s[44:47], s12 offen nt lds
    s_mov_b32 m0, s15
    s_add_u32 s15, s15, 1024
    buffer_load_dwordx4 v8, s[48:51], s12 offen nt lds
    s_add_u32 s12, s12, 28672
    s_mov_b32 m0, s14
    s_add_u32 s14, s14, 1024
    buffer_load_dwordx4 v7, s[44:47], s12 offen nt lds
    s_mov_b32 m0, s15
    s_add_u32 s15, s15, 1024
    buffer_load_dwordx4 v9, s[48:51], s12 offen nt lds
    s_add_u32 s12, s12, 28672
    s_add_u32 s11, s11, 1
    s_cmp_lt_u32 s11, 4
    s_cbranch_scc1 L_AM_GU
    s_lshl_b32 s10, s9, 15
    s_add_u32 s44, s32, s10
    s_addc_u32 s45, s33, 0
    s_and_b32 s45, s45, 0xffff
    s_mov_b32 s46, 32768
    s_mov_b32 s47, 0x20000
    s_add_u32 m0, s13, 65536
    s_mov_b32 s10, s13
    buffer_load_dwordx4 v10, s[44:47], s10 offen nt lds
    s_add_u32 m0, m0, 1024
    s_add_u32 s10, s10, 1024
    buffer_load_dwordx4 v11, s[44:47], s10 offen nt lds
    s_add_u32 m0, m0, 1024
    s_add_u32 s10, s10, 1024
    buffer_load_dwordx4 v12, s[44:47], s10 offen nt lds
    s_add_u32 m0, m0, 1024
    s_add_u32 s10, s10, 1024
    buffer_load_dwordx4 v13, s[44:47], s10 offen nt lds
    s_add_u32 m0, m0, 1024
    s_add_u32 s10, s10, 1024
    buffer_load_dwordx4 v10, s[44:47], s10 offen nt lds
    s_add_u32 m0, m0, 1024
    s_add_u32 s10, s10, 1024
    buffer_load_dwordx4 v11, s[44:47], s10 offen nt lds
    s_add_u32 m0, m0, 1024
    s_add_u32 s10, s10, 1024
    buffer_load_dwordx4 v12, s[44:47], s10 offen nt lds
    s_add_u32 m0, m0, 1024
    s_add_u32 s10, s10, 1024
    buffer_load_dwordx4 v13, s[44:47], s10 offen nt lds
    v_mov_b32 v20, 134976
    v_mov_b32 v21, 1
    s_mov_b64 exec, 1
    ds_add_u32 v20, v21
    s_mov_b64 exec, -1
    v_lshrrev_b32 v14, 2, v5
    v_lshrrev_b32 v17, 3, v5
    v_lshl_add_u32 v14, v4, 3, v14
    v_and_b32 v16, 1, v4
    v_lshl_or_b32 v17, v16, 1, v17
    v_and_b32 v16, 1, v5
    v_lshl_or_b32 v17, v16, 2, v17
    s_lshl_b32 s10, s3, 2
    s_add_u32 s10, s10, s6
    v_xor_b32 v17, s10, v17
    v_lshlrev_b32 v6, 7, v14
    v_lshl_add_u32 v6, v17, 4, v6
    v_bfe_u32 v17, v5, 1, 1
    v_lshl_add_u32 v6, v17, 3, v6
    v_lshl_add_u32 v6, v16, 15, v6
    v_add_u32 v6, 0, v6
    v_xor_b32 v27, 64, v6
L_AM_MLP:
    s_add_u32 s16, s40, 98304
    s_addc_u32 s17, s41, 0
    s_add_u32 s18, s40, 102400
    s_addc_u32 s19, s41, 0
    s_add_u32 s20, s40, 106496
    s_addc_u32 s21, s41, 0
    s_add_u32 s22, s40, 110592
    s_addc_u32 s23, s41, 0
    s_lshl_b32 s10, s6, 8
    v_lshlrev_b32 v8, 4, v5
    v_add_u32 v8, s10, v8
    global_load_dwordx4 v[224:227], v8, s[16:17] offset:0 sc1
    global_load_dwordx4 v[228:231], v8, s[16:17] offset:2048 sc1
    global_load_dwordx4 v[232:235], v8, s[18:19] offset:0 sc1
    global_load_dwordx4 v[236:239], v8, s[20:21] offset:0 sc1
    global_load_dwordx4 v[240:243], v8, s[20:21] offset:2048 sc1
    global_load_dwordx4 v[244:247], v8, s[22:23] offset:0 sc1
    s_add_u32 s64, s40, 65536
    s_addc_u32 s65, s41, 0
    v_lshl_add_u32 v9, v4, 12, v8
    v_lshrrev_b32 v10, 2, v8
    v_add_u32 v10, v10, v4
    v_lshlrev_b32 v10, 1, v10
    v_add_u32 v11, 131072, v10
    s_lshl_b32 s10, s6, 5
    s_add_u32 s10, s10, 134656
    v_lshlrev_b32 v16, 3, v4
    v_add_u32 v16, s10, v16
    v_and_b32 v17, 31, v1
    v_lshlrev_b32 v17, 3, v17
    v_add_u32 v17, 134656, v17
    v_lshlrev_b32 v18, 4, v4
    v_add_u32 v19, 134912, v18
    v_add_u32 v18, 131072, v18
    v_lshrrev_b32 v20, 2, v5
    v_min_u32 v20, 2, v20
    v_mul_u32_u24 v21, 1088, v20
    v_add_u32 v18, v18, v21
    v_lshlrev_b32 v26, 4, v4
    v_lshl_add_u32 v26, v20, 6, v26
    s_lshl_b32 s10, s6, 4
    s_add_u32 s10, s10, 134912
    v_lshlrev_b32 v23, 2, v4
    v_add_u32 v23, s10, v23
    v_mov_b32 v25, s42
    s_mov_b32 s13, 0xff
    s_bfe_u32 s10, s6, 0x10001
    s_lshl_b32 s10, s10, 6
    s_and_b32 s11, s6, 1
    v_and_b32 v21, 1, v4
    v_xor_b32 v20, v5, v21
    v_lshl_add_u32 v20, v4, 4, v20
    v_add_u32 v20, s10, v20
    v_lshrrev_b32 v24, 1, v20
    v_mul_u32_u24 v24, 1792, v24
    v_and_b32 v20, 1, v20
    v_lshl_add_u32 v24, v20, 4, v24
    s_lshl_b32 s10, s9, 5
    s_lshl_b32 s11, s11, 3
    s_mov_b32 s58, 0x00010001
    s_mov_b32 s59, s58
    s_lshl_b64 s[58:59], s[58:59], s11
    s_mov_b32 s66, 0x00ff00ff
    s_mov_b32 s67, s66
    s_lshl_b64 s[66:67], s[66:67], s11
    s_add_u32 s60, s10, 131072
    s_add_u32 s60, s40, s60
    s_addc_u32 s61, s41, 0
    s_lshl_b32 s10, s9, 10
    s_and_b32 s11, s6, 3
    s_lshl_b32 s11, s11, 8
    s_add_u32 s10, s10, s11
    s_add_u32 s44, s10, 1179648
    s_add_u32 s44, s40, s44
    s_addc_u32 s45, s41, 0
    s_add_u32 s46, s44, 65536
    s_addc_u32 s47, s45, 0
    s_xor_b32 s48, s44, 1024
    s_mov_b32 s49, s45
    s_xor_b32 s50, s46, 1024
    s_mov_b32 s51, s47
    s_and_b32 s3, s9, 1
    s_lshl_b32 s3, s3, 9
    v_add_u32 v18, s3, v18
    s_mov_b32 s52, 0x00010001
    s_mov_b32 s53, s52
    s_mov_b32 s62, 0x01110111
    s_mov_b32 s63, s62
    global_load_dwordx4 v[56:59], v26, s[48:49] sc1
    global_load_dwordx4 v[32:35], v9, s[64:65] sc1
    global_load_dwordx4 v[36:39], v9, s[64:65] offset:2048 sc1
    s_waitcnt vmcnt(9)
    s_barrier
    s_cmp_ge_u32 s6, 4
    s_cbranch_scc1 L_AM_TRD
    ds_read_b64_tr_b16 v[64:65], v27 offset:0
    ds_read_b64_tr_b16 v[66:67], v27 offset:512
    ds_read_b64_tr_b16 v[68:69], v27 offset:4096
    ds_read_b64_tr_b16 v[70:71], v27 offset:4608
    ds_read_b64_tr_b16 v[72:73], v27 offset:8192
    ds_read_b64_tr_b16 v[74:75], v27 offset:8704
    ds_read_b64_tr_b16 v[76:77], v27 offset:12288
    ds_read_b64_tr_b16 v[78:79], v27 offset:12800
    ds_read_b64_tr_b16 v[80:81], v27 offset:16384
    ds_read_b64_tr_b16 v[82:83], v27 offset:16896
    ds_read_b64_tr_b16 v[84:85], v27 offset:20480
    ds_read_b64_tr_b16 v[86:87], v27 offset:20992
    ds_read_b64_tr_b16 v[88:89], v27 offset:24576
    ds_read_b64_tr_b16 v[90:91], v27 offset:25088
    ds_read_b64_tr_b16 v[92:93], v27 offset:28672
    ds_read_b64_tr_b16 v[94:95], v27 offset:29184
    ds_read_b64_tr_b16 v[96:97], v6 offset:0
    ds_read_b64_tr_b16 v[98:99], v6 offset:512
    ds_read_b64_tr_b16 v[100:101], v6 offset:4096
    ds_read_b64_tr_b16 v[102:103], v6 offset:4608
    ds_read_b64_tr_b16 v[104:105], v6 offset:8192
    ds_read_b64_tr_b16 v[106:107], v6 offset:8704
    ds_read_b64_tr_b16 v[108:109], v6 offset:12288
    ds_read_b64_tr_b16 v[110:111], v6 offset:12800
    ds_read_b64_tr_b16 v[112:113], v6 offset:16384
    ds_read_b64_tr_b16 v[114:115], v6 offset:16896
    ds_read_b64_tr_b16 v[116:117], v6 offset:20480
    ds_read_b64_tr_b16 v[118:119], v6 offset:20992
    ds_read_b64_tr_b16 v[120:121], v6 offset:24576
    ds_read_b64_tr_b16 v[122:123], v6 offset:25088
    ds_read_b64_tr_b16 v[124:125], v6 offset:28672
    ds_read_b64_tr_b16 v[126:127], v6 offset:29184
    s_branch L_AM_NOTR
L_AM_TRD:
    ds_read_b64_tr_b16 v[160:161], v7 offset:0
    ds_read_b64_tr_b16 v[162:163], v7 offset:4096
    v_xor_b32 v28, 8, v7
    ds_read_b64_tr_b16 v[164:165], v28 offset:0
    ds_read_b64_tr_b16 v[166:167], v28 offset:4096
    v_xor_b32 v28, 16, v7
    ds_read_b64_tr_b16 v[168:169], v28 offset:0
    ds_read_b64_tr_b16 v[170:171], v28 offset:4096
    v_xor_b32 v28, 24, v7
    ds_read_b64_tr_b16 v[172:173], v28 offset:0
    ds_read_b64_tr_b16 v[174:175], v28 offset:4096
    v_xor_b32 v28, 32, v7
    ds_read_b64_tr_b16 v[176:177], v28 offset:0
    ds_read_b64_tr_b16 v[178:179], v28 offset:4096
    v_xor_b32 v28, 40, v7
    ds_read_b64_tr_b16 v[180:181], v28 offset:0
    ds_read_b64_tr_b16 v[182:183], v28 offset:4096
    v_xor_b32 v28, 48, v7
    ds_read_b64_tr_b16 v[184:185], v28 offset:0
    ds_read_b64_tr_b16 v[186:187], v28 offset:4096
    v_xor_b32 v28, 56, v7
    ds_read_b64_tr_b16 v[188:189], v28 offset:0
    ds_read_b64_tr_b16 v[190:191], v28 offset:4096
L_AM_NOTR:
    s_mov_b32 s26, 0xffff0000
    s_mov_b32 s27, 0
    s_mov_b32 s28, 0
    s_mov_b32 s29, 0x0000ffff
    s_mov_b32 s30, 0
    s_mov_b32 s31, 0xffff0000
    s_mov_b32 s43, 0
    s_waitcnt vmcnt(3)
    s_branch L_pck_18
L_poll_16:
    global_load_dwordx4 v[224:227], v8, s[16:17] offset:0 sc1
    global_load_dwordx4 v[228:231], v8, s[16:17] offset:2048 sc1
    global_load_dwordx4 v[232:235], v8, s[18:19] offset:0 sc1
    global_load_dwordx4 v[236:239], v8, s[20:21] offset:0 sc1
    global_load_dwordx4 v[240:243], v8, s[20:21] offset:2048 sc1
    global_load_dwordx4 v[244:247], v8, s[22:23] offset:0 sc1
    s_waitcnt vmcnt(0)
L_pck_18:
    v_bitop3_b32 v20, v224, v225, s42 bitop3:0x7e
    v_bitop3_b32 v21, v226, v227, s42 bitop3:0x7e
    v_bitop3_b32 v22, v228, v229, s42 bitop3:0x7e
    v_or3_b32 v20, v20, v21, v22
    v_bitop3_b32 v21, v230, v231, s42 bitop3:0x7e
    v_bitop3_b32 v22, v232, v233, s42 bitop3:0x7e
    v_or3_b32 v20, v20, v21, v22
    v_bitop3_b32 v21, v234, v235, s42 bitop3:0x7e
    v_bitop3_b32 v22, v236, v237, s42 bitop3:0x7e
    v_or3_b32 v20, v20, v21, v22
    v_bitop3_b32 v21, v238, v239, s42 bitop3:0x7e
    v_bitop3_b32 v22, v240, v241, s42 bitop3:0x7e
    v_or3_b32 v20, v20, v21, v22
    v_bitop3_b32 v21, v242, v243, s42 bitop3:0x7e
    v_bitop3_b32 v22, v244, v245, s42 bitop3:0x7e
    v_or3_b32 v20, v20, v21, v22
    v_bitop3_b32 v21, v246, v247, s42 bitop3:0x7e
    v_or_b32 v20, v20, v21
    v_and_b32 v20, 0xff, v20
    v_cmp_ne_u32 vcc, 0, v20
    s_cbranch_vccz L_ok_17
    s_mov_b64 exec, vcc
    s_add_u32 s43, s43, 1
    s_cmp_lt_u32 s43, 1048576
    s_cbranch_scc1 L_poll_16
L_ok_17:
    s_mov_b64 exec, -1
    v_cndmask_b32 v12, v224, v225, s[26:27]
    v_cndmask_b32 v12, v12, v226, s[28:29]
    v_cndmask_b32 v12, v12, v227, s[30:31]
    v_cndmask_b32 v14, v228, v229, s[26:27]
    v_cndmask_b32 v14, v14, v230, s[28:29]
    v_cndmask_b32 v14, v14, v231, s[30:31]
    v_cndmask_b32 v13, v232, v233, s[26:27]
    v_cndmask_b32 v13, v13, v234, s[28:29]
    v_cndmask_b32 v13, v13, v235, s[30:31]
    v_cndmask_b32 v20, v236, v237, s[26:27]
    v_cndmask_b32 v20, v20, v238, s[28:29]
    v_cndmask_b32 v20, v20, v239, s[30:31]
    v_cndmask_b32 v21, v240, v241, s[26:27]
    v_cndmask_b32 v21, v21, v242, s[28:29]
    v_cndmask_b32 v21, v21, v243, s[30:31]
    v_cndmask_b32 v22, v244, v245, s[26:27]
    v_cndmask_b32 v22, v22, v246, s[28:29]
    v_cndmask_b32 v22, v22, v247, s[30:31]
    v_xor_b32 v12, s42, v12
    v_xor_b32 v13, s42, v13
    v_xor_b32 v14, s42, v14
    v_xor_b32 v20, s42, v20
    v_xor_b32 v21, s42, v21
    v_xor_b32 v22, s42, v22
    v_add_f32 v12, v12, v20
    v_add_f32 v14, v14, v21
    v_add_f32 v13, v13, v22
    v_cvt_pk_bf16_f32 v12, 0, v12
    v_cvt_pk_bf16_f32 v14, 0, v14
    v_cvt_pk_bf16_f32 v13, 0, v13
    v_add_f32 v13, 1.0, v13
    v_cvt_pk_bf16_f32 v13, 0, v13
    v_lshlrev_b32 v15, 16, v60
    ds_write_b16_d16_hi v11, v13 offset:1088
    ds_write_b16_d16_hi v11, v14 offset:2176
    s_waitcnt lgkmcnt(0)
    s_mov_b32 s43, 0
L_poll_19:
    global_load_dwordx4 v[32:35], v9, s[64:65] sc1
    global_load_dwordx4 v[36:39], v9, s[64:65] offset:2048 sc1
    s_waitcnt vmcnt(0)
    v_xor_b32 v32, s42, v32
    v_xor_b32 v33, s42, v33
    v_xor_b32 v34, s42, v34
    v_xor_b32 v35, s42, v35
    v_xor_b32 v36, s42, v36
    v_xor_b32 v37, s42, v37
    v_xor_b32 v38, s42, v38
    v_xor_b32 v39, s42, v39
    v_or3_b32 v20, v32, v33, v34
    v_or3_b32 v20, v20, v35, v36
    v_or3_b32 v20, v20, v37, v38
    v_or_b32 v20, v20, v39
    v_and_b32 v20, 0xff, v20
    v_cmp_ne_u32 vcc, 0, v20
    s_cbranch_vccz L_ok_20
    s_mov_b64 exec, vcc
    s_add_u32 s43, s43, 1
    s_cmp_lt_u32 s43, 1048576
    s_cbranch_scc1 L_poll_19
L_ok_20:
    s_mov_b64 exec, -1
    v_add_f32 v32, v32, v36
    v_add_f32 v33, v33, v37
    v_add_f32 v34, v34, v38
    v_add_f32 v35, v35, v39
    s_nop 1
    v_permlane32_swap_b32 v32, v34
    v_permlane32_swap_b32 v33, v35
    v_add_f32 v32, v32, v34
    v_add_f32 v33, v33, v35
    s_nop 1
    v_permlane16_swap_b32 v32, v33
    v_add_f32 v32, v32, v33
    v_cvt_pk_bf16_f32 v32, 0, v32
    v_mul_f32 v32, v12, v32
    v_cvt_pk_bf16_f32 v32, 0, v32
    v_add_f32 v32, v15, v32
    v_cvt_pk_bf16_f32 v32, 0, v32
    v_mul_f32 v33, v32, v13
    v_mul_f32 v21, v32, v32
    v_cvt_pk_bf16_f32 v33, v33, v33
    ds_write_b16 v11, v33
    v_add_f32_dpp v20, v32, v32 row_ror:1 row_mask:0xf bank_mask:0xf
    v_add_f32_dpp v21, v21, v21 row_ror:1 row_mask:0xf bank_mask:0xf
    s_nop 0
    v_add_f32_dpp v20, v20, v20 row_ror:2 row_mask:0xf bank_mask:0xf
    v_add_f32_dpp v21, v21, v21 row_ror:2 row_mask:0xf bank_mask:0xf
    s_nop 0
    v_add_f32_dpp v20, v20, v20 row_ror:4 row_mask:0xf bank_mask:0xf
    v_add_f32_dpp v21, v21, v21 row_ror:4 row_mask:0xf bank_mask:0xf
    s_nop 0
    v_add_f32_dpp v20, v20, v20 row_ror:8 row_mask:0xf bank_mask:0xf
    v_add_f32_dpp v21, v21, v21 row_ror:8 row_mask:0xf bank_mask:0xf
    s_mov_b64 exec, s[52:53]
    ds_write_b64 v16, v[20:21]
    s_mov_b64 exec, -1
    s_waitcnt lgkmcnt(0)
    s_barrier
    s_cmp_ge_u32 s6, 4
    s_cbranch_scc1 L_AM_DOWN
    ds_read_b128 v[128:131], v18 offset:0
    ds_read_b128 v[132:135], v18 offset:64
    ds_read_b128 v[136:139], v18 offset:128
    ds_read_b128 v[140:143], v18 offset:192
    ds_read_b128 v[144:147], v18 offset:256
    ds_read_b128 v[148:151], v18 offset:320
    ds_read_b128 v[152:155], v18 offset:384
    ds_read_b128 v[156:159], v18 offset:448
    ds_read_b64 v[36:37], v17
    s_waitcnt lgkmcnt(8)
    v_mfma_f32_16x16x32_bf16 v[32:35], v[64:67], v[128:131], 0
    s_waitcnt lgkmcnt(7)
    v_mfma_f32_16x16x32_bf16 v[32:35], v[68:71], v[132:135], v[32:35]
    s_waitcnt lgkmcnt(6)
    v_mfma_f32_16x16x32_bf16 v[32:35], v[72:75], v[136:139], v[32:35]
    s_waitcnt lgkmcnt(5)
    v_mfma_f32_16x16x32_bf16 v[32:35], v[76:79], v[140:143], v[32:35]
    s_waitcnt lgkmcnt(4)
    v_mfma_f32_16x16x32_bf16 v[32:35], v[80:83], v[144:147], v[32:35]
    s_waitcnt lgkmcnt(3)
    v_mfma_f32_16x16x32_bf16 v[32:35], v[84:87], v[148:151], v[32:35]
    s_waitcnt lgkmcnt(2)
    v_mfma_f32_16x16x32_bf16 v[32:35], v[88:91], v[152:155], v[32:35]
    s_waitcnt lgkmcnt(1)
    v_mfma_f32_16x16x32_bf16 v[32:35], v[92:95], v[156:159], v[32:35]
    s_waitcnt lgkmcnt(0)
    v_mfma_f32_16x16x32_bf16 v[28:31], v[96:99], v[128:131], 0
    v_add_f32_dpp v36, v36, v36 row_ror:1 row_mask:0xf bank_mask:0xf
    v_add_f32_dpp v37, v37, v37 row_ror:1 row_mask:0xf bank_mask:0xf
    v_mfma_f32_16x16x32_bf16 v[28:31], v[100:103], v[132:135], v[28:31]
    v_add_f32_dpp v36, v36, v36 row_ror:2 row_mask:0xf bank_mask:0xf
    v_add_f32_dpp v37, v37, v37 row_ror:2 row_mask:0xf bank_mask:0xf
    v_mfma_f32_16x16x32_bf16 v[28:31], v[104:107], v[136:139], v[28:31]
    v_add_f32_dpp v36, v36, v36 row_ror:4 row_mask:0xf bank_mask:0xf
    v_add_f32_dpp v37, v37, v37 row_ror:4 row_mask:0xf bank_mask:0xf
    v_bfi_b32 v32, s13, v25, v32
    v_bfi_b32 v33, s13, v25, v33
    v_bfi_b32 v34, s13, v25, v34
    v_bfi_b32 v35, s13, v25, v35
    s_mov_b64 exec, s[62:63]
    global_store_dwordx4 v26, v[32:35], s[44:45]
    s_mov_b64 exec, -1
    v_mfma_f32_16x16x32_bf16 v[28:31], v[108:111], v[140:143], v[28:31]
    v_mfma_f32_16x16x32_bf16 v[28:31], v[112:115], v[144:147], v[28:31]
    v_mfma_f32_16x16x32_bf16 v[28:31], v[116:119], v[148:151], v[28:31]
    v_mfma_f32_16x16x32_bf16 v[28:31], v[120:123], v[152:155], v[28:31]
    v_mfma_f32_16x16x32_bf16 v[28:31], v[124:127], v[156:159], v[28:31]
    global_load_dwordx4 v[56:59], v26, s[48:49] sc1
    v_add_f32_dpp v36, v36, v36 row_ror:8 row_mask:0xf bank_mask:0xf
    v_add_f32_dpp v37, v37, v37 row_ror:8 row_mask:0xf bank_mask:0xf
    v_mov_b32 v38, v36
    v_mov_b32 v39, v37
    s_nop 0
    v_permlane16_swap_b32 v36, v38
    v_permlane16_swap_b32 v37, v39
    v_add_f32 v36, v36, v38
    v_add_f32 v37, v37, v39
    v_mul_f32 v36, 0x3b000000, v36
    v_mul_f32 v37, 0x3b000000, v37
    v_fma_f32 v37, -v36, v36, v37
    v_max_f32 v37, 0, v37
    v_cvt_pk_bf16_f32 v36, 0, v36
    v_cvt_pk_bf16_f32 v37, 0, v37
    v_add_f32 v37, 0x3727c5ac, v37
    v_cvt_pk_bf16_f32 v37, 0, v37
    v_sqrt_f32 v37, v37
    s_nop 0
    v_cvt_pk_bf16_f32 v37, 0, v37
    v_rcp_f32 v37, v37
    s_nop 0
    v_sub_f32 v36, 0, v36
    s_mov_b32 s43, 0
    s_waitcnt vmcnt(0)
    s_branch L_GX_F2
L_GX_F:
    global_load_dwordx4 v[56:59], v26, s[48:49] sc1
    s_waitcnt vmcnt(0)
L_GX_F2:
    v_xor_b32 v56, s42, v56
    v_xor_b32 v57, s42, v57
    v_xor_b32 v58, s42, v58
    v_xor_b32 v59, s42, v59
    v_or3_b32 v20, v56, v57, v58
    v_or_b32 v20, v20, v59
    v_and_b32 v20, 0xff, v20
    v_cmp_ne_u32 vcc, 0, v20
    s_cbranch_vccz L_GX_OK
    s_add_u32 s43, s43, 1
    s_cmp_lt_u32 s43, 256
    s_cbranch_scc1 L_GX_F
    s_mov_b64 exec, s[62:63]
    global_store_dwordx4 v26, v[32:35], s[46:47] sc1
    s_mov_b64 exec, -1
L_GX_S:
    global_load_dwordx4 v[56:59], v26, s[50:51] sc1
    s_waitcnt vmcnt(0)
    v_xor_b32 v56, s42, v56
    v_xor_b32 v57, s42, v57
    v_xor_b32 v58, s42, v58
    v_xor_b32 v59, s42, v59
    v_or3_b32 v20, v56, v57, v58
    v_or_b32 v20, v20, v59
    v_and_b32 v20, 0xff, v20
    v_cmp_ne_u32 vcc, 0, v20
    s_cbranch_vccz L_GX_OK
    s_add_u32 s43, s43, 1
    s_cmp_lt_u32 s43, 1048576
    s_cbranch_scc1 L_GX_S
L_GX_OK:
    v_add_f32 v28, v28, v56
    v_add_f32 v29, v29, v57
    v_add_f32 v30, v30, v58
    v_add_f32 v31, v31, v59
    v_mov_b32_dpp v56, v28 row_ror:8 row_mask:0xf bank_mask:0xf
    v_mov_b32_dpp v57, v29 row_ror:8 row_mask:0xf bank_mask:0xf
    v_mov_b32_dpp v58, v30 row_ror:8 row_mask:0xf bank_mask:0xf
    v_mov_b32_dpp v59, v31 row_ror:8 row_mask:0xf bank_mask:0xf
    v_fmac_f32_dpp v28, v28, v36 row_ror:12 row_mask:0xf bank_mask:0x1
    v_fmac_f32_dpp v29, v29, v36 row_ror:12 row_mask:0xf bank_mask:0x1
    v_fmac_f32_dpp v30, v30, v36 row_ror:12 row_mask:0xf bank_mask:0x1
    v_fmac_f32_dpp v31, v31, v36 row_ror:12 row_mask:0xf bank_mask:0x1
    v_fma_f32 v28, v28, v37, v56
    v_fma_f32 v29, v29, v37, v57
    v_fma_f32 v30, v30, v37, v58
    v_fma_f32 v31, v31, v37, v59
    v_cvt_pk_bf16_f32 v28, 0, v28
    v_cvt_pk_bf16_f32 v29, 0, v29
    v_cvt_pk_bf16_f32 v30, 0, v30
    v_cvt_pk_bf16_f32 v31, 0, v31
    s_nop 0
    v_permlane16_swap_b32 v28, v30
    v_permlane16_swap_b32 v29, v31
    v_mul_f32 v28, v28, v30
    v_mul_f32 v29, v29, v31
    v_cvt_pk_bf16_f32 v28, v28, v29
    s_mov_b64 exec, s[52:53]
    ds_write_b32 v23, v28
    s_waitcnt lgkmcnt(0)
    s_barrier
    s_barrier
    s_mov_b64 exec, s[62:63]
    global_store_dwordx4 v26, v[32:35], s[46:47] sc1
    s_endpgm
L_AM_DOWN:
    s_barrier
    s_lshl_b64 exec, s[58:59], 0
    ds_read_b128 v[192:195], v19
    s_lshl_b64 exec, s[58:59], 1
    ds_read_b128 v[196:199], v19
    s_lshl_b64 exec, s[58:59], 2
    ds_read_b128 v[200:203], v19
    s_lshl_b64 exec, s[58:59], 3
    ds_read_b128 v[204:207], v19
    s_lshl_b64 exec, s[58:59], 4
    ds_read_b128 v[208:211], v19
    s_lshl_b64 exec, s[58:59], 5
    ds_read_b128 v[212:215], v19
    s_lshl_b64 exec, s[58:59], 6
    ds_read_b128 v[216:219], v19
    s_lshl_b64 exec, s[58:59], 7
    ds_read_b128 v[220:223], v19
    s_mov_b64 exec, -1
    s_waitcnt lgkmcnt(7)
    v_mfma_f32_16x16x32_bf16 v[28:31], v[160:163], v[192:195], 0
    s_waitcnt lgkmcnt(6)
    v_mfma_f32_16x16x32_bf16 v[28:31], v[164:167], v[196:199], v[28:31]
    s_waitcnt lgkmcnt(5)
    v_mfma_f32_16x16x32_bf16 v[28:31], v[168:171], v[200:203], v[28:31]
    s_waitcnt lgkmcnt(4)
    v_mfma_f32_16x16x32_bf16 v[28:31], v[172:175], v[204:207], v[28:31]
    s_waitcnt lgkmcnt(3)
    v_mfma_f32_16x16x32_bf16 v[28:31], v[176:179], v[208:211], v[28:31]
    s_waitcnt lgkmcnt(2)
    v_mfma_f32_16x16x32_bf16 v[28:31], v[180:183], v[212:215], v[28:31]
    s_waitcnt lgkmcnt(1)
    v_mfma_f32_16x16x32_bf16 v[28:31], v[184:187], v[216:219], v[28:31]
    s_waitcnt lgkmcnt(0)
    v_mfma_f32_16x16x32_bf16 v[28:31], v[188:191], v[220:223], v[28:31]
    s_nop 7
    v_bfi_b32 v28, s13, v25, v28
    v_bfi_b32 v29, s13, v25, v29
    v_bfi_b32 v30, s13, v25, v30
    v_bfi_b32 v31, s13, v25, v31
    s_mov_b64 exec, s[66:67]
    global_store_dwordx4 v24, v[28:31], s[60:61] sc1
    s_barrier
    s_endpgm
L_exit:
    s_endpgm
L_code_end:
.section .rodata,"a"
.p2align 6
.amdhsa_kernel adaLN_cond__sliding_block_cached__glu_gated_bilinear__decode_kernel
  .amdhsa_next_free_vgpr 256
  .amdhsa_next_free_sgpr 102
  .amdhsa_accum_offset 256
  .amdhsa_group_segment_fixed_size 0
  .amdhsa_kernarg_size 112
  .amdhsa_user_sgpr_count 2
  .amdhsa_user_sgpr_kernarg_segment_ptr 1
  .amdhsa_system_sgpr_workgroup_id_x 1
.end_amdhsa_kernel
```
